```python
import torch

def _softmax(x, axis=-1):
    return torch.softmax(x, dim=axis)

def _gelu(x):
    return torch.nn.functional.gelu(x, approximate='tanh')

def _silu(x):
    return torch.nn.functional.silu(x)

def _sigmoid(x):
    return torch.sigmoid(x)

def _layernorm(x, axis=-1, eps=1e-05):
    m = x.mean(dim=axis, keepdim=True)
    v = x.var(dim=axis, keepdim=True, unbiased=False)
    return (x - m) / torch.sqrt(v + eps)

def _scatter_add(tgt, idx, src, axis=0):
    return tgt.clone().index_add_(axis, idx, src)

def _segment_sum(src, seg, n):
    out = torch.zeros((n,) + src.shape[1:], dtype=src.dtype)
    return out.index_add_(0, seg, src)

def _pad(x, pw):
    flat = tuple((v for pair in reversed(pw) for v in pair))
    return torch.nn.functional.pad(x, flat)
kernel_name = 'adaLN_cond__compressed_kv_cla__dense_activation_squared_relu__decode'

def setup_inputs():

    _w = lambda a: (lambda t: t.to(torch.bfloat16) if t.is_floating_point() else t)(torch.as_tensor(a))

    def _A_setup():
        B, H, Sq, Sk, D, M = (2, 32, 1, 4096, 128, 640)
        Dc = 4 * D
        return {'x': _w((lambda *s: torch.randn(*s, dtype=torch.bfloat16) * 0.05)(B, Sq, M)), 'c_kv': _w((lambda *s: torch.randn(*s, dtype=torch.bfloat16) * 1.6)(B, Sk, Dc)), 'w_q': _w((lambda *s: torch.randn(*s, dtype=torch.bfloat16) * 0.8)(M, H, D) * M ** (-0.5)), 'w_uk': _w((lambda *s: torch.randn(*s, dtype=torch.bfloat16) * 0.8)(Dc, H, D) * Dc ** (-0.5)), 'w_uv': _w((lambda *s: torch.randn(*s, dtype=torch.bfloat16) * 1.6)(Dc, H, D) * Dc ** (-0.5)), 'w_o': _w((lambda *s: torch.randn(*s, dtype=torch.bfloat16) * 1.6)(H, D, M) * (H * D) ** (-0.5))}
    _A_in = _A_setup()

    def _B_setup():
        B, S, D, F = (2, 1, 640, 1728)
        return {'x': _w((lambda *s: torch.randn(*s, dtype=torch.bfloat16) * 0.05)(B, S, D)), 'w1': _w((lambda *s: torch.randn(*s, dtype=torch.bfloat16) * 0.05)(D, F)), 'b1': _w((lambda *s: torch.randn(*s, dtype=torch.bfloat16) * 0.2)(F)), 'w2': _w((lambda *s: torch.randn(*s, dtype=torch.bfloat16) * 0.05)(F, D)), 'b2': _w((lambda *s: torch.randn(*s, dtype=torch.bfloat16) * 1.6)(D))}
    _B_in = _B_setup()
    return {'A_x': _A_in['x'], 'A_c_kv': _A_in['c_kv'], 'A_w_q': _A_in['w_q'], 'A_w_uk': _A_in['w_uk'], 'A_w_uv': _A_in['w_uv'], 'A_w_o': _A_in['w_o'], 'B_x': _B_in['x'], 'B_w1': _B_in['w1'], 'B_b1': _B_in['b1'], 'B_w2': _B_in['w2'], 'B_b2': _B_in['b2'], 'c': _w((lambda *s: torch.randn(*s, dtype=torch.bfloat16) * 0.1)(2, 640) * 8.0), 'w_mod': _w((lambda *s: torch.randn(*s, dtype=torch.bfloat16) * 0.1)(640, 6 * 640) * 640 ** (-0.5) * 8.0)}

def reference(A_x, A_c_kv, A_w_q, A_w_uk, A_w_uv, A_w_o, B_x, B_w1, B_b1, B_w2, B_b2, c, w_mod):

    def _A_ref(x, c_kv, w_q, w_uk, w_uv, w_o):
        B, Sq, M = (x.shape[0], x.shape[1], x.shape[2])
        Sk = c_kv.shape[1]
        H, D = (w_q.shape[1], w_q.shape[2])
        q = torch.einsum('bqm,mhd->bhqd', x, w_q)
        k = torch.einsum('bkc,chd->bhkd', c_kv, w_uk)
        v = torch.einsum('bkc,chd->bhkd', c_kv, w_uv)
        scores = torch.einsum('bhqd,bhkd->bhqk', q, k) * D ** (-0.5)
        off = Sk - Sq
        qi = torch.arange(Sq)[:, None]
        kj = torch.arange(Sk)[None, :]
        cmask = kj <= qi + off
        scores = torch.where(cmask[None, None], scores, -1000000000.0)
        p = _softmax(scores, axis=-1)
        ctx = torch.einsum('bhqk,bhkd->bhqd', p, v)
        return torch.einsum('bhqd,hdm->bqm', ctx, w_o)

    def _B_ref(x, w1, b1, w2, b2):
        h = torch.einsum('bsd,df->bsf', x, w1) + b1
        zero = torch.zeros_like(h)
        r = torch.where(h > zero, h, zero)
        h = r * r
        out = torch.einsum('bsf,fd->bsd', h, w2) + b2
        return out
    x = A_x
    mod = (_silu(c) @ w_mod).reshape(c.shape[0], 6, 1, -1)
    sa, ca, ga, sb, cb, gb = (mod[:, 0].clone(), mod[:, 1].clone(), mod[:, 2].clone(), mod[:, 3].clone(), mod[:, 4].clone(), mod[:, 5].clone())
    h = _layernorm(x, axis=-1) * (1 + ca) + sa
    x = x + ga * _A_ref(h, A_c_kv, A_w_q, A_w_uk, A_w_uv, A_w_o)
    h = _layernorm(x, axis=-1) * (1 + cb) + sb
    x = x + gb * _B_ref(h, B_w1, B_b1, B_w2, B_b2)
    return x
```

```asm
; @launch grid=(256,1,1) block=(512,1,1) lds=163840
.amdgcn_target "amdgcn-amd-amdhsa--gfx950"
.text
.globl adaLN_cond__compressed_kv_cla__dense_activation_squared_relu__decode_kernel
.p2align 8
.type adaLN_cond__compressed_kv_cla__dense_activation_squared_relu__decode_kernel,@function
adaLN_cond__compressed_kv_cla__dense_activation_squared_relu__decode_kernel:
    s_cmp_ge_u32 s2, 256
    s_cbranch_scc1 L_exit
    s_load_dwordx16 s[16:31], s[0:1], 0
    s_load_dwordx16 s[32:47], s[0:1], 64
    v_and_b32 v1, 63, v0
    v_and_b32 v2, 15, v0
    v_bfe_u32 v3, v0, 4, 2
    v_lshrrev_b32 v4, 6, v0
    s_lshr_b32 s5, s2, 4
    v_readfirstlane_b32 s4, v4
    s_and_b32 s6, s2, 7
    s_mov_b32 s15, 0
    s_waitcnt lgkmcnt(0)
    s_load_dword s7, s[46:47], 0
    s_bitcmp1_b32 s2, 3
    s_cbranch_scc1 L_setB
    v_mov_b32 v16, 161664
    v_mov_b32 v18, 0
    v_mov_b32 v19, 0
    v_mov_b32 v20, 0
    v_mov_b32 v21, 0
    v_mov_b32 v61, 9437184
    ds_write_b128 v16, v[18:21]
    s_mul_i32 s48, s6, 13
    s_add_u32 s48, s48, s5
    s_waitcnt lgkmcnt(0)
    s_barrier
    s_cmp_ge_u32 s4, 4
    s_cbranch_scc1 Lm1hi_3
    s_cmp_ge_u32 s5, 13
    s_cbranch_scc1 Lm1skip_1
    s_cmp_ge_u32 s48, 100
    s_cbranch_scc1 Lm1skip_1
    s_mul_i32 s49, s48, 52429
    s_lshr_b32 s49, s49, 20
    s_mul_i32 s50, s49, 20
    s_sub_u32 s50, s48, s50
    s_cmp_lt_u32 s4, 2
    s_cbranch_scc0 Lm1w2_6
    v_and_b32 v16, 31, v1
    v_lshrrev_b32 v17, 5, v1
    v_mul_u32_u24 v17, 1280, v17
    v_lshl_add_u32 v16, v16, 3, v17
    global_load_dwordx2 v[24:25], v16, s[16:17]
    global_load_dwordx2 v[26:27], v16, s[16:17] offset:256
    global_load_dwordx2 v[28:29], v16, s[16:17] offset:512
    global_load_dwordx2 v[30:31], v16, s[16:17] offset:768
    global_load_dwordx2 v[32:33], v16, s[16:17] offset:1024
    s_lshl_b32 s9, s50, 6
    s_lshl_b32 s10, s4, 5
    s_add_u32 s9, s9, s10
    v_lshl_add_u32 v18, v2, 1, s9
    global_load_ushort v34, v18, s[16:17]
    global_load_ushort v35, v18, s[16:17] offset:1280
    s_branch Lm1dma_7
Lm1w2_6:
    s_cmp_eq_u32 s4, 2
    s_cbranch_scc0 Lm1dma_7
    s_lshl_b32 s9, s49, 8
    v_lshlrev_b32 v16, 2, v1
    v_add_u32 v17, s9, v16
    global_load_dword v24, v17, s[38:39]
    global_load_dword v25, v17, s[38:39] offset:1280
Lm1dma_7:
    v_lshrrev_b32 v40, 3, v1
    v_and_b32 v41, 7, v1
    v_bfe_u32 v42, v40, 1, 1
    s_and_b32 s9, s4, 1
    s_lshl_b32 s9, s9, 1
    v_or_b32 v42, s9, v42
    v_lshrrev_b32 v43, 1, v41
    v_xor_b32 v43, v43, v42
    v_and_b32 v44, 1, v41
    v_lshl_or_b32 v43, v43, 1, v44
    v_cmp_lt_u32 vcc, 3, v43
    v_lshlrev_b32 v44, 4, v43
    v_add_u32 v45, 1216, v44
    v_cndmask_b32 v44, v44, v45, vcc
    s_lshl_b32 s9, s49, 7
    s_lshl_b32 s10, s4, 3
    s_add_u32 s9, s9, s10
    v_add_u32 v40, s9, v40
    v_mul_u32_u24 v40, 7680, v40
    s_lshl_b32 s10, s50, 6
    v_add3_u32 v40, v40, v44, s10
    s_lshl_b32 s11, s4, 10
    s_add_u32 s11, s11, 131072
    s_mov_b32 m0, s11
    s_add_u32 s11, s11, 4096
    global_load_lds_dwordx4 v40, s[40:41] nt
    v_add_u32 v40, 245760, v40
    s_mov_b32 m0, s11
    s_add_u32 s11, s11, 4096
    global_load_lds_dwordx4 v40, s[40:41] nt
    v_add_u32 v40, 245760, v40
    s_mov_b32 m0, s11
    s_add_u32 s11, s11, 4096
    global_load_lds_dwordx4 v40, s[40:41] nt
    v_add_u32 v40, 245760, v40
    s_mov_b32 m0, s11
    s_add_u32 s11, s11, 4096
    global_load_lds_dwordx4 v40, s[40:41] nt
    s_cmp_eq_u32 s4, 2
    s_cbranch_scc0 Lm1a_8
    s_waitcnt vmcnt(4)
    v_lshlrev_b32 v20, 16, v24
    v_and_b32 v21, 0xffff0000, v24
    v_mul_f32 v22, 0xbfb8aa3b, v20
    v_mul_f32 v23, 0xbfb8aa3b, v21
    v_exp_f32 v22, v22
    v_exp_f32 v23, v23
    s_nop 0
    v_add_f32 v22, 1.0, v22
    v_add_f32 v23, 1.0, v23
    v_rcp_f32 v22, v22
    v_rcp_f32 v23, v23
    s_nop 0
    v_mul_f32 v20, v20, v22
    v_mul_f32 v21, v21, v23
    v_cvt_pk_bf16_f32 v26, v20, v21
    v_lshlrev_b32 v20, 16, v25
    v_and_b32 v21, 0xffff0000, v25
    v_mul_f32 v22, 0xbfb8aa3b, v20
    v_mul_f32 v23, 0xbfb8aa3b, v21
    v_exp_f32 v22, v22
    v_exp_f32 v23, v23
    s_nop 0
    v_add_f32 v22, 1.0, v22
    v_add_f32 v23, 1.0, v23
    v_rcp_f32 v22, v22
    v_rcp_f32 v23, v23
    s_nop 0
    v_mul_f32 v20, v20, v22
    v_mul_f32 v21, v21, v23
    v_cvt_pk_bf16_f32 v27, v20, v21
    v_add_u32 v16, 147712, v16
    ds_write_b32 v16, v26
    ds_write_b32 v16, v27 offset:256
    s_branch Lm1j_9
Lm1a_8:
    s_cmp_lt_u32 s4, 2
    s_cbranch_scc0 Lm1j_9
    v_lshrrev_b32 v16, 2, v2
    v_and_b32 v17, 3, v2
    v_lshrrev_b32 v18, 1, v16
    v_and_b32 v19, 1, v3
    v_lshl_or_b32 v18, v19, 1, v18
    v_lshl_add_u32 v19, v3, 3, v16
    v_lshlrev_b32 v19, 7, v19
    v_lshl_add_u32 v19, v17, 3, v19
    v_add_u32 v19, 131072, v19
    v_xor_b32 v20, s4, v18
    v_lshl_add_u32 v58, v20, 5, v19
    s_add_u32 s9, s4, 2
    v_xor_b32 v20, s9, v18
    v_lshl_add_u32 v59, v20, 5, v19
    v_and_b32 v20, 1, v2
    v_lshlrev_b32 v20, 8, v20
    v_lshl_add_u32 v20, v3, 4, v20
    v_add_u32 v60, 147712, v20
    s_mul_i32 s9, s49, 640
    s_lshl_b32 s10, s50, 5
    s_add_u32 s9, s9, s10
    s_lshl_b32 s10, s4, 4
    s_add_u32 s9, s9, s10
    v_add_u32 v61, s9, v2
    v_lshlrev_b32 v61, 4, v61
    v_add_u32 v61, 65536, v61
    s_cmp_eq_u32 s49, 0
    s_cselect_b32 s54, 1.0, 0
    s_waitcnt vmcnt(4)
    v_lshlrev_b32 v36, 16, v24
    v_and_b32 v37, 0xffff0000, v24
    v_lshlrev_b32 v38, 16, v25
    v_and_b32 v39, 0xffff0000, v25
    v_lshlrev_b32 v40, 16, v26
    v_and_b32 v41, 0xffff0000, v26
    v_lshlrev_b32 v42, 16, v27
    v_and_b32 v43, 0xffff0000, v27
    v_lshlrev_b32 v44, 16, v28
    v_and_b32 v45, 0xffff0000, v28
    v_lshlrev_b32 v46, 16, v29
    v_and_b32 v47, 0xffff0000, v29
    v_lshlrev_b32 v48, 16, v30
    v_and_b32 v49, 0xffff0000, v30
    v_lshlrev_b32 v50, 16, v31
    v_and_b32 v51, 0xffff0000, v31
    v_lshlrev_b32 v52, 16, v32
    v_and_b32 v53, 0xffff0000, v32
    v_lshlrev_b32 v54, 16, v33
    v_and_b32 v55, 0xffff0000, v33
    v_add_f32 v22, v36, v37
    v_add_f32 v23, v38, v39
    v_add_f32 v22, v22, v23
    v_add_f32 v23, v40, v41
    v_add_f32 v22, v22, v23
    v_add_f32 v23, v42, v43
    v_add_f32 v22, v22, v23
    v_add_f32 v23, v44, v45
    v_add_f32 v22, v22, v23
    v_add_f32 v23, v46, v47
    v_add_f32 v22, v22, v23
    v_add_f32 v23, v48, v49
    v_add_f32 v22, v22, v23
    v_add_f32 v23, v50, v51
    v_add_f32 v22, v22, v23
    v_add_f32 v23, v52, v53
    v_add_f32 v22, v22, v23
    v_add_f32 v23, v54, v55
    v_add_f32 v22, v22, v23
    s_nop 1
    v_add_f32_dpp v22, v22, v22 quad_perm:[1,0,3,2] row_mask:0xf bank_mask:0xf
    s_nop 1
    v_add_f32_dpp v22, v22, v22 quad_perm:[2,3,0,1] row_mask:0xf bank_mask:0xf
    s_nop 1
    v_add_f32_dpp v22, v22, v22 row_half_mirror row_mask:0xf bank_mask:0xf
    s_nop 1
    v_add_f32_dpp v22, v22, v22 row_mirror row_mask:0xf bank_mask:0xf
    v_mov_b32 v23, v22
    s_nop 1
    v_permlane16_swap_b32 v22, v23
    s_nop 1
    v_add_f32 v22, v22, v23
    v_mul_f32 v22, 0x3acccccd, v22
    v_sub_f32 v36, v36, v22
    v_mul_f32 v23, v36, v36
    v_sub_f32 v37, v37, v22
    v_fmac_f32 v23, v37, v37
    v_sub_f32 v38, v38, v22
    v_fmac_f32 v23, v38, v38
    v_sub_f32 v39, v39, v22
    v_fmac_f32 v23, v39, v39
    v_sub_f32 v40, v40, v22
    v_fmac_f32 v23, v40, v40
    v_sub_f32 v41, v41, v22
    v_fmac_f32 v23, v41, v41
    v_sub_f32 v42, v42, v22
    v_fmac_f32 v23, v42, v42
    v_sub_f32 v43, v43, v22
    v_fmac_f32 v23, v43, v43
    v_sub_f32 v44, v44, v22
    v_fmac_f32 v23, v44, v44
    v_sub_f32 v45, v45, v22
    v_fmac_f32 v23, v45, v45
    v_sub_f32 v46, v46, v22
    v_fmac_f32 v23, v46, v46
    v_sub_f32 v47, v47, v22
    v_fmac_f32 v23, v47, v47
    v_sub_f32 v48, v48, v22
    v_fmac_f32 v23, v48, v48
    v_sub_f32 v49, v49, v22
    v_fmac_f32 v23, v49, v49
    v_sub_f32 v50, v50, v22
    v_fmac_f32 v23, v50, v50
    v_sub_f32 v51, v51, v22
    v_fmac_f32 v23, v51, v51
    v_sub_f32 v52, v52, v22
    v_fmac_f32 v23, v52, v52
    v_sub_f32 v53, v53, v22
    v_fmac_f32 v23, v53, v53
    v_sub_f32 v54, v54, v22
    v_fmac_f32 v23, v54, v54
    v_sub_f32 v55, v55, v22
    v_fmac_f32 v23, v55, v55
    s_nop 1
    v_add_f32_dpp v23, v23, v23 quad_perm:[1,0,3,2] row_mask:0xf bank_mask:0xf
    s_nop 1
    v_add_f32_dpp v23, v23, v23 quad_perm:[2,3,0,1] row_mask:0xf bank_mask:0xf
    s_nop 1
    v_add_f32_dpp v23, v23, v23 row_half_mirror row_mask:0xf bank_mask:0xf
    s_nop 1
    v_add_f32_dpp v23, v23, v23 row_mirror row_mask:0xf bank_mask:0xf
    v_mov_b32 v24, v23
    s_nop 1
    v_permlane16_swap_b32 v23, v24
    s_nop 1
    v_add_f32 v23, v23, v24
    v_mov_b32 v24, 0x3727c5ac
    v_fmac_f32 v24, 0x3acccccd, v23
    v_rsq_f32 v24, v24
    s_nop 1
    v_readlane_b32 s50, v22, 0
    v_readlane_b32 s51, v22, 32
    v_readlane_b32 s52, v24, 0
    v_readlane_b32 s53, v24, 32
    v_lshlrev_b32 v20, 16, v34
    v_lshlrev_b32 v21, 16, v35
    v_subrev_f32 v20, s50, v20
    v_subrev_f32 v21, s51, v21
    v_mul_f32 v56, s52, v20
    v_mul_f32 v57, s53, v21
Lm1j_9:
    s_waitcnt lgkmcnt(0)
    s_mul_i32 s8, s7, 1664525
    s_add_u32 s8, s8, 1013904223
    s_and_b32 s8, s8, 0xBFFFBFFF
    s_cmp_eq_u32 s8, s7
    s_cbranch_scc0 Ltag_10
    s_xor_b32 s8, s8, 1
Ltag_10:
    v_mov_b32 v16, 161664
    v_mov_b32 v17, 1
    s_waitcnt vmcnt(0) lgkmcnt(0)
    s_mov_b64 exec, 1
    ds_add_u32 v16, v17
    s_mov_b64 exec, -1
    s_cmp_lt_u32 s4, 2
    s_cbranch_scc0 Lm1ck_4
    s_mov_b32 s14, 0
Lspin_11:
    ds_read_b32 v17, v16 offset:0
    s_add_u32 s14, s14, 1
    s_cmp_gt_u32 s14, 2000000
    s_cbranch_scc1 Lspo_12
    s_waitcnt lgkmcnt(0)
    v_readfirstlane_b32 s9, v17
    s_cmp_lt_u32 s9, 4
    s_cbranch_scc1 Lspin_11
Lspo_12:
    s_waitcnt lgkmcnt(0)
    ds_read_b128 v[64:67], v60 offset:0
    ds_read_b64_tr_b16 v[80:81], v58 offset:0
    ds_read_b64_tr_b16 v[82:83], v58 offset:512
    ds_read_b64_tr_b16 v[96:97], v59 offset:0
    ds_read_b64_tr_b16 v[98:99], v59 offset:512
    ds_read_b128 v[68:71], v60 offset:64
    ds_read_b64_tr_b16 v[84:85], v58 offset:4096
    ds_read_b64_tr_b16 v[86:87], v58 offset:4608
    ds_read_b64_tr_b16 v[100:101], v59 offset:4096
    ds_read_b64_tr_b16 v[102:103], v59 offset:4608
    ds_read_b128 v[72:75], v60 offset:128
    ds_read_b64_tr_b16 v[88:89], v58 offset:8192
    ds_read_b64_tr_b16 v[90:91], v58 offset:8704
    ds_read_b64_tr_b16 v[104:105], v59 offset:8192
    ds_read_b64_tr_b16 v[106:107], v59 offset:8704
    ds_read_b128 v[76:79], v60 offset:192
    ds_read_b64_tr_b16 v[92:93], v58 offset:12288
    ds_read_b64_tr_b16 v[94:95], v58 offset:12800
    ds_read_b64_tr_b16 v[108:109], v59 offset:12288
    ds_read_b64_tr_b16 v[110:111], v59 offset:12800
    v_mov_b32 v34, 0
    v_mov_b32 v35, s8
    s_waitcnt lgkmcnt(15)
    v_mfma_f32_16x16x32_bf16 v[24:27], v[64:67], v[80:83], 0
    v_mfma_f32_16x16x32_bf16 v[28:31], v[64:67], v[96:99], 0
    s_waitcnt lgkmcnt(10)
    v_mfma_f32_16x16x32_bf16 v[24:27], v[68:71], v[84:87], v[24:27]
    v_mfma_f32_16x16x32_bf16 v[28:31], v[68:71], v[100:103], v[28:31]
    s_waitcnt lgkmcnt(5)
    v_mfma_f32_16x16x32_bf16 v[24:27], v[72:75], v[88:91], v[24:27]
    v_mfma_f32_16x16x32_bf16 v[28:31], v[72:75], v[104:107], v[28:31]
    s_waitcnt lgkmcnt(0)
    v_mfma_f32_16x16x32_bf16 v[24:27], v[76:79], v[92:95], v[24:27]
    v_mfma_f32_16x16x32_bf16 v[28:31], v[76:79], v[108:111], v[28:31]
    s_mov_b64 exec, 0xffff
    s_nop 6
    v_add_f32 v28, s54, v28
    v_add_f32 v29, s54, v29
    v_fma_f32 v32, v56, v28, v24
    v_fma_f32 v33, v57, v29, v25
    global_store_dwordx4 v61, v[32:35], s[46:47] sc1
    s_mov_b64 exec, -1
    v_mov_b32 v16, 161664
    v_mov_b32 v17, 1
    s_mov_b64 exec, 1
    ds_add_u32 v16, v17 offset:12
    s_mov_b64 exec, -1
    s_branch Lm1ck2_5
Lm1ck_4:
    v_mov_b32 v16, 161664
    s_mov_b32 s14, 0
Lspin_13:
    ds_read_b32 v17, v16 offset:12
    s_add_u32 s14, s14, 1
    s_cmp_gt_u32 s14, 2000000
    s_cbranch_scc1 Lspo_14
    s_waitcnt lgkmcnt(0)
    v_readfirstlane_b32 s9, v17
    s_cmp_lt_u32 s9, 2
    s_cbranch_scc1 Lspin_13
Lspo_14:
    s_waitcnt lgkmcnt(0)
Lm1ck2_5:
    s_lshl_b32 s60, s6, 3
    s_lshr_b32 s9, s5, 1
    s_add_u32 s60, s60, s9
    s_lshl_b32 s9, s60, 7
    s_add_u32 s9, s9, s4
    s_add_u32 s9, s9, 0
    s_lshl_b32 s9, s9, 10
    s_lshl_b32 s11, s4, 10
    s_add_u32 s11, s11, 0
    s_add_u32 s10, s4, 0
    s_and_b32 s10, s10, 15
    s_and_b32 s13, s10, 7
    s_lshl_b32 s13, s13, 1
    s_lshr_b32 s10, s10, 3
    s_or_b32 s10, s10, s13
    v_xor_b32 v16, s10, v1
    v_lshl_add_u32 v100, v16, 4, s9
    v_add_u32 v100, 0, v100
    s_add_u32 s10, s4, 8
    s_and_b32 s10, s10, 15
    s_and_b32 s13, s10, 7
    s_lshl_b32 s13, s13, 1
    s_lshr_b32 s10, s10, 3
    s_or_b32 s10, s10, s13
    v_xor_b32 v16, s10, v1
    v_lshl_add_u32 v101, v16, 4, s9
    v_add_u32 v101, 8192, v101
    s_mov_b32 m0, s11
    s_add_u32 s11, s11, 8192
    global_load_lds_dwordx4 v100, s[18:19] nt
    v_add_u32 v100, 16384, v100
    s_mov_b32 m0, s11
    s_add_u32 s11, s11, 8192
    global_load_lds_dwordx4 v101, s[18:19] nt
    v_add_u32 v101, 16384, v101
    s_mov_b32 m0, s11
    s_add_u32 s11, s11, 8192
    global_load_lds_dwordx4 v100, s[18:19] nt
    v_add_u32 v100, 16384, v100
    s_mov_b32 m0, s11
    s_add_u32 s11, s11, 8192
    global_load_lds_dwordx4 v101, s[18:19] nt
    v_add_u32 v101, 16384, v101
    s_mov_b32 m0, s11
    s_add_u32 s11, s11, 8192
    global_load_lds_dwordx4 v100, s[18:19] nt
    v_add_u32 v100, 16384, v100
    s_mov_b32 m0, s11
    s_add_u32 s11, s11, 8192
    global_load_lds_dwordx4 v101, s[18:19] nt
    v_add_u32 v101, 16384, v101
    s_mov_b32 m0, s11
    s_add_u32 s11, s11, 8192
    global_load_lds_dwordx4 v100, s[18:19] nt
    v_add_u32 v100, 16384, v100
    s_mov_b32 m0, s11
    s_add_u32 s11, s11, 8192
    global_load_lds_dwordx4 v101, s[18:19] nt
    v_add_u32 v101, 16384, v101
    s_mov_b32 m0, s11
    s_add_u32 s11, s11, 8192
    global_load_lds_dwordx4 v100, s[18:19] nt
    v_add_u32 v100, 16384, v100
    s_mov_b32 m0, s11
    s_add_u32 s11, s11, 8192
    global_load_lds_dwordx4 v101, s[18:19] nt
    v_add_u32 v101, 16384, v101
    s_mov_b32 m0, s11
    s_add_u32 s11, s11, 8192
    global_load_lds_dwordx4 v100, s[18:19] nt
    v_add_u32 v100, 16384, v100
    s_mov_b32 m0, s11
    s_add_u32 s11, s11, 8192
    global_load_lds_dwordx4 v101, s[18:19] nt
    v_add_u32 v101, 16384, v101
    s_mov_b32 m0, s11
    s_add_u32 s11, s11, 8192
    global_load_lds_dwordx4 v100, s[18:19] nt
    v_add_u32 v100, 16384, v100
    s_mov_b32 m0, s11
    s_add_u32 s11, s11, 8192
    global_load_lds_dwordx4 v101, s[18:19] nt
    v_add_u32 v101, 16384, v101
    s_mov_b32 m0, s11
    s_add_u32 s11, s11, 8192
    global_load_lds_dwordx4 v100, s[18:19] nt
    s_mov_b32 m0, s11
    s_add_u32 s11, s11, 8192
    global_load_lds_dwordx4 v101, s[18:19] nt
    s_branch Lm1after_2
Lm1hi_3:
    s_waitcnt lgkmcnt(0)
    s_mul_i32 s8, s7, 1664525
    s_add_u32 s8, s8, 1013904223
    s_and_b32 s8, s8, 0xBFFFBFFF
    s_cmp_eq_u32 s8, s7
    s_cbranch_scc0 Ltag_15
    s_xor_b32 s8, s8, 1
Ltag_15:
    s_branch Lm1ck_4
Lm1skip_1:
    s_waitcnt lgkmcnt(0)
    s_mul_i32 s8, s7, 1664525
    s_add_u32 s8, s8, 1013904223
    s_and_b32 s8, s8, 0xBFFFBFFF
    s_cmp_eq_u32 s8, s7
    s_cbranch_scc0 Ltag_16
    s_xor_b32 s8, s8, 1
Ltag_16:
    v_mov_b32 v16, 161664
    v_mov_b32 v17, 1
    s_mov_b64 exec, 1
    ds_add_u32 v16, v17 offset:0
    s_mov_b64 exec, -1
    s_cmp_lt_u32 s4, 2
    s_cbranch_scc0 Lsk_17
    v_mov_b32 v17, 1
    s_mov_b64 exec, 1
    ds_add_u32 v16, v17 offset:12
    s_mov_b64 exec, -1
Lsk_17:
    s_branch Lm1ck_4
Lm1after_2:
    s_lshl_b32 s48, s6, 3
    s_lshr_b32 s9, s5, 1
    s_add_u32 s48, s48, s9
    s_and_b32 s49, s5, 1
    s_lshr_b32 s50, s48, 5
    s_lshl_b32 s9, s50, 5
    s_lshl_b32 s10, s49, 4
    s_add_u32 s9, s9, s10
    s_mul_i32 s9, s9, 1408
    s_add_u32 s9, s9, 393216
    s_mov_b32 s10, 762601
    s_mov_b32 s12, 131072
    v_add_u32 v16, 0, v0
    v_lshl_add_u32 v100, v16, 4, s9
    v_mul_u32_u24 v17, s10, v16
    v_lshrrev_b32 v17, 24, v17
    v_mul_u32_u24 v18, 22, v17
    v_sub_u32 v18, v16, v18
    v_lshrrev_b32 v19, 2, v17
    v_and_b32 v20, 3, v17
    v_mul_u32_u24 v19, 1040, v19
    v_lshl_add_u32 v19, v20, 8, v19
    v_mul_u32_u24 v20, 12, v18
    v_add3_u32 v103, v19, v20, s12
    v_add_u32 v106, 4, v103
    v_cmp_eq_u32 vcc, 21, v18
    v_mov_b32 v20, 156416
    s_nop 0
    v_cndmask_b32 v106, v106, v20, vcc
    v_add_u32 v16, 512, v0
    v_lshl_add_u32 v101, v16, 4, s9
    v_mul_u32_u24 v17, s10, v16
    v_lshrrev_b32 v17, 24, v17
    v_mul_u32_u24 v18, 22, v17
    v_sub_u32 v18, v16, v18
    v_lshrrev_b32 v19, 2, v17
    v_and_b32 v20, 3, v17
    v_mul_u32_u24 v19, 1040, v19
    v_lshl_add_u32 v19, v20, 8, v19
    v_mul_u32_u24 v20, 12, v18
    v_add3_u32 v104, v19, v20, s12
    v_add_u32 v107, 4, v104
    v_cmp_eq_u32 vcc, 21, v18
    v_mov_b32 v20, 156416
    s_nop 0
    v_cndmask_b32 v107, v107, v20, vcc
    v_add_u32 v16, 1024, v0
    v_lshl_add_u32 v102, v16, 4, s9
    v_mul_u32_u24 v17, s10, v16
    v_lshrrev_b32 v17, 24, v17
    v_mul_u32_u24 v18, 22, v17
    v_sub_u32 v18, v16, v18
    v_lshrrev_b32 v19, 2, v17
    v_and_b32 v20, 3, v17
    v_mul_u32_u24 v19, 1040, v19
    v_lshl_add_u32 v19, v20, 8, v19
    v_mul_u32_u24 v20, 12, v18
    v_add3_u32 v105, v19, v20, s12
    v_add_u32 v108, 4, v105
    v_cmp_eq_u32 vcc, 21, v18
    v_mov_b32 v20, 156416
    s_nop 0
    v_cndmask_b32 v108, v108, v20, vcc
    v_and_b32 v16, 7, v2
    v_lshlrev_b32 v16, 1, v16
    v_lshrrev_b32 v17, 3, v2
    v_or_b32 v16, v16, v17
    s_lshl_b32 s9, s4, 4
    v_add_u32 v17, s9, v2
    v_lshlrev_b32 v17, 10, v17
    v_lshl_add_u32 v17, v3, 8, v17
    v_lshl_add_u32 v110, v16, 4, v17
    v_mul_u32_u24 v17, 1040, v2
    v_lshl_add_u32 v17, v3, 8, v17
    v_add_u32 v111, 131072, v17
    v_lshrrev_b32 v16, 2, v2
    v_and_b32 v17, 3, v2
    v_lshl_add_u32 v18, v3, 2, v16
    v_and_b32 v19, 7, v18
    v_lshlrev_b32 v19, 1, v19
    v_lshrrev_b32 v20, 3, v18
    v_or_b32 v19, v19, v20
    v_lshrrev_b32 v20, 1, v17
    v_xor_b32 v19, v19, v20
    s_and_b32 s9, s4, 1
    s_lshl_b32 s9, s9, 3
    v_xor_b32 v19, s9, v19
    v_and_b32 v20, 1, v17
    v_lshlrev_b32 v20, 3, v20
    v_lshl_add_u32 v20, v18, 10, v20
    s_lshr_b32 s9, s4, 1
    s_lshl_b32 s9, s9, 8
    v_add_u32 v20, s9, v20
    v_xor_b32 v21, 0, v19
    v_lshl_add_u32 v112, v21, 4, v20
    v_add_u32 v116, 65536, v112
    v_xor_b32 v21, 2, v19
    v_lshl_add_u32 v113, v21, 4, v20
    v_add_u32 v117, 65536, v113
    v_xor_b32 v21, 4, v19
    v_lshl_add_u32 v114, v21, 4, v20
    v_add_u32 v118, 65536, v114
    v_xor_b32 v21, 6, v19
    v_lshl_add_u32 v115, v21, 4, v20
    v_add_u32 v119, 65536, v115
    v_lshlrev_b32 v16, 5, v2
    v_add_u32 v120, 148224, v16
    s_lshl_b32 s9, s4, 2
    v_add_u32 v121, s9, v120
    s_lshr_b32 s9, s4, 1
    s_lshl_b32 s9, s9, 10
    s_and_b32 s10, s4, 1
    s_lshl_b32 s10, s10, 3
    s_add_u32 s9, s9, s10
    s_add_u32 s9, s9, 152320
    v_lshl_add_u32 v122, v1, 4, s9
    v_lshlrev_b32 v123, 4, v1
    v_add_u32 v123, 152320, v123
    s_lshr_b32 s9, s4, 1
    s_lshl_b32 s9, s9, 4
    v_add_u32 v16, s9, v2
    v_mul_u32_u24 v16, 72, v16
    s_and_b32 s10, s4, 1
    s_mul_i32 s10, s10, 36
    v_lshl_add_u32 v17, v3, 1, s10
    v_add_u32 v16, v16, v17
    v_lshlrev_b32 v16, 2, v16
    v_add_u32 v124, 0, v16
    v_mul_u32_u24 v16, 12, v0
    v_add_u32 v125, 0, v16
    s_lshl_b32 s9, s50, 1
    s_add_u32 s9, s9, s49
    s_lshl_b32 s9, s9, 5
    s_and_b32 s10, s48, 31
    s_add_u32 s9, s9, s10
    s_mul_i32 s9, s9, 24576
    s_add_u32 s9, s9, 1048576
    v_lshl_add_u32 v126, v0, 4, s9
    v_add_u32 v127, 8192, v126
    v_add_u32 v99, 16384, v126
    s_lshl_b32 s9, s50, 1
    s_add_u32 s9, s9, s49
    s_lshl_b32 s9, s9, 5
    s_and_b32 s10, s48, 31
    s_add_u32 s9, s9, s10
    s_lshl_b32 s9, s9, 4
    s_add_u32 s9, s9, 9371648
    v_mov_b32 v98, s9
    s_waitcnt vmcnt(0)
    s_barrier
    v_xor_b32 v16, 0, v110
    ds_read_b128 v[128:131], v16
    v_xor_b32 v16, 16, v110
    ds_read_b128 v[132:135], v16
    v_xor_b32 v16, 32, v110
    ds_read_b128 v[136:139], v16
    v_xor_b32 v16, 48, v110
    ds_read_b128 v[140:143], v16
    v_xor_b32 v16, 64, v110
    ds_read_b128 v[144:147], v16
    v_xor_b32 v16, 80, v110
    ds_read_b128 v[148:151], v16
    v_xor_b32 v16, 96, v110
    ds_read_b128 v[152:155], v16
    v_xor_b32 v16, 112, v110
    ds_read_b128 v[156:159], v16
    v_xor_b32 v16, 128, v110
    ds_read_b128 v[160:163], v16
    v_xor_b32 v16, 144, v110
    ds_read_b128 v[164:167], v16
    v_xor_b32 v16, 160, v110
    ds_read_b128 v[168:171], v16
    v_xor_b32 v16, 176, v110
    ds_read_b128 v[172:175], v16
    v_xor_b32 v16, 192, v110
    ds_read_b128 v[176:179], v16
    v_xor_b32 v16, 208, v110
    ds_read_b128 v[180:183], v16
    v_xor_b32 v16, 224, v110
    ds_read_b128 v[184:187], v16
    v_xor_b32 v16, 240, v110
    ds_read_b128 v[188:191], v16
    ds_read_b64_tr_b16 v[192:193], v112 offset:0
    ds_read_b64_tr_b16 v[194:195], v112 offset:16384
    ds_read_b64_tr_b16 v[196:197], v112 offset:32768
    ds_read_b64_tr_b16 v[198:199], v112 offset:49152
    ds_read_b64_tr_b16 v[200:201], v116 offset:0
    ds_read_b64_tr_b16 v[202:203], v116 offset:16384
    ds_read_b64_tr_b16 v[204:205], v116 offset:32768
    ds_read_b64_tr_b16 v[206:207], v116 offset:49152
    ds_read_b64_tr_b16 v[208:209], v113 offset:0
    ds_read_b64_tr_b16 v[210:211], v113 offset:16384
    ds_read_b64_tr_b16 v[212:213], v113 offset:32768
    ds_read_b64_tr_b16 v[214:215], v113 offset:49152
    ds_read_b64_tr_b16 v[216:217], v117 offset:0
    ds_read_b64_tr_b16 v[218:219], v117 offset:16384
    ds_read_b64_tr_b16 v[220:221], v117 offset:32768
    ds_read_b64_tr_b16 v[222:223], v117 offset:49152
    ds_read_b64_tr_b16 v[224:225], v114 offset:0
    ds_read_b64_tr_b16 v[226:227], v114 offset:16384
    ds_read_b64_tr_b16 v[228:229], v114 offset:32768
    ds_read_b64_tr_b16 v[230:231], v114 offset:49152
    ds_read_b64_tr_b16 v[232:233], v118 offset:0
    ds_read_b64_tr_b16 v[234:235], v118 offset:16384
    ds_read_b64_tr_b16 v[236:237], v118 offset:32768
    ds_read_b64_tr_b16 v[238:239], v118 offset:49152
    ds_read_b64_tr_b16 v[240:241], v115 offset:0
    ds_read_b64_tr_b16 v[242:243], v115 offset:16384
    ds_read_b64_tr_b16 v[244:245], v115 offset:32768
    ds_read_b64_tr_b16 v[246:247], v115 offset:49152
    ds_read_b64_tr_b16 v[248:249], v119 offset:0
    ds_read_b64_tr_b16 v[250:251], v119 offset:16384
    ds_read_b64_tr_b16 v[252:253], v119 offset:32768
    ds_read_b64_tr_b16 v[254:255], v119 offset:49152
    s_waitcnt lgkmcnt(0)
    s_barrier
    s_lshl_b32 s9, s4, 6
    v_add_u32 v44, s9, v1
    s_mov_b32 s10, 838861
    s_lshl_b32 s9, s6, 9
    s_mul_i32 s13, s5, 80
    s_lshl_b32 s11, s4, 10
    s_add_u32 s11, s11, 32768
    v_mul_u32_u24 v45, s10, v44
    v_lshrrev_b32 v45, 22, v45
    v_mul_u32_u24 v46, 5, v45
    v_sub_u32 v46, v44, v46
    v_add_u32 v45, s9, v45
    v_mul_u32_u24 v45, 1280, v45
    v_lshl_add_u32 v45, v46, 4, v45
    v_add_u32 v5, s13, v45
    s_mov_b32 s55, s11
    s_add_u32 s11, s11, 8192
    v_add_u32 v44, 512, v44
    v_mul_u32_u24 v45, s10, v44
    v_lshrrev_b32 v45, 22, v45
    v_mul_u32_u24 v46, 5, v45
    v_sub_u32 v46, v44, v46
    v_add_u32 v45, s9, v45
    v_mul_u32_u24 v45, 1280, v45
    v_lshl_add_u32 v45, v46, 4, v45
    v_add_u32 v6, s13, v45
    s_mov_b32 s56, s11
    s_add_u32 s11, s11, 8192
    v_add_u32 v44, 512, v44
    v_mul_u32_u24 v45, s10, v44
    v_lshrrev_b32 v45, 22, v45
    v_mul_u32_u24 v46, 5, v45
    v_sub_u32 v46, v44, v46
    v_add_u32 v45, s9, v45
    v_mul_u32_u24 v45, 1280, v45
    v_lshl_add_u32 v45, v46, 4, v45
    v_add_u32 v7, s13, v45
    s_mov_b32 s57, s11
    s_add_u32 s11, s11, 8192
    v_add_u32 v44, 512, v44
    v_mul_u32_u24 v45, s10, v44
    v_lshrrev_b32 v45, 22, v45
    v_mul_u32_u24 v46, 5, v45
    v_sub_u32 v46, v44, v46
    v_add_u32 v45, s9, v45
    v_mul_u32_u24 v45, 1280, v45
    v_lshl_add_u32 v45, v46, 4, v45
    v_add_u32 v8, s13, v45
    s_mov_b32 s58, s11
    s_add_u32 s11, s11, 8192
    v_add_u32 v44, 512, v44
    v_mul_u32_u24 v45, s10, v44
    v_lshrrev_b32 v45, 22, v45
    v_mul_u32_u24 v46, 5, v45
    v_sub_u32 v46, v44, v46
    v_add_u32 v45, s9, v45
    v_mul_u32_u24 v45, 1280, v45
    v_lshl_add_u32 v45, v46, 4, v45
    v_add_u32 v9, s13, v45
    s_mov_b32 s59, s11
    s_add_u32 s11, s11, 8192
    v_add_u32 v44, 512, v44
    v_mov_b32 v27, s8
Lag_18:
    global_load_dwordx4 v[16:19], v100, s[46:47] sc1
    global_load_dwordx4 v[20:23], v101, s[46:47] sc1
    s_cmp_lt_u32 s4, 6
    s_cbranch_scc0 Lag6_19
    global_load_dwordx4 v[24:27], v102, s[46:47] sc1
Lag6_19:
    s_waitcnt vmcnt(0)
    v_xor_b32 v40, s8, v19
    v_xor_b32 v41, s8, v23
    v_xor_b32 v27, s8, v27
    v_or3_b32 v40, v40, v41, v27
    v_cmp_ne_u32 vcc, 0, v40
    s_cbranch_vccz Lok_20
    s_add_u32 s15, s15, 1
    s_cmp_lt_u32 s15, 200000
    s_cbranch_scc1 Lag_18
Lok_20:
    ds_write_b32 v103, v16
    ds_write2_b32 v106, v17, v18 offset0:0 offset1:1
    ds_write_b32 v104, v20
    ds_write2_b32 v107, v21, v22 offset0:0 offset1:1
    s_cmp_lt_u32 s4, 6
    s_cbranch_scc0 Lag7_21
    ds_write_b32 v105, v24
    ds_write2_b32 v108, v25, v26 offset0:0 offset1:1
Lag7_21:
    s_waitcnt lgkmcnt(0)
    s_barrier
    ds_read_b128 v[32:35], v111 offset:0
    ds_read_b128 v[36:39], v111 offset:16
    ds_read_b128 v[40:43], v111 offset:32
    ds_read_b128 v[44:47], v111 offset:48
    ds_read_b128 v[48:51], v111 offset:64
    ds_read_b128 v[52:55], v111 offset:80
    ds_read_b128 v[56:59], v111 offset:96
    ds_read_b128 v[60:63], v111 offset:112
    ds_read_b128 v[64:67], v111 offset:128
    ds_read_b128 v[68:71], v111 offset:144
    ds_read_b128 v[72:75], v111 offset:160
    ds_read_b128 v[76:79], v111 offset:176
    ds_read_b128 v[80:83], v111 offset:192
    ds_read_b128 v[84:87], v111 offset:208
    ds_read_b128 v[88:91], v111 offset:224
    ds_read_b128 v[92:95], v111 offset:240
    s_waitcnt lgkmcnt(15)
    v_mfma_f32_16x16x32_bf16 v[20:23], v[128:131], v[32:35], 0
    s_waitcnt lgkmcnt(14)
    v_mfma_f32_16x16x32_bf16 v[20:23], v[132:135], v[36:39], v[20:23]
    s_waitcnt lgkmcnt(13)
    v_mfma_f32_16x16x32_bf16 v[20:23], v[136:139], v[40:43], v[20:23]
    s_waitcnt lgkmcnt(12)
    v_mfma_f32_16x16x32_bf16 v[20:23], v[140:143], v[44:47], v[20:23]
    s_waitcnt lgkmcnt(11)
    v_mfma_f32_16x16x32_bf16 v[20:23], v[144:147], v[48:51], v[20:23]
    s_waitcnt lgkmcnt(10)
    v_mfma_f32_16x16x32_bf16 v[20:23], v[148:151], v[52:55], v[20:23]
    s_waitcnt lgkmcnt(9)
    v_mfma_f32_16x16x32_bf16 v[20:23], v[152:155], v[56:59], v[20:23]
    s_waitcnt lgkmcnt(8)
    v_mfma_f32_16x16x32_bf16 v[20:23], v[156:159], v[60:63], v[20:23]
    s_waitcnt lgkmcnt(7)
    v_mfma_f32_16x16x32_bf16 v[20:23], v[160:163], v[64:67], v[20:23]
    s_waitcnt lgkmcnt(6)
    v_mfma_f32_16x16x32_bf16 v[20:23], v[164:167], v[68:71], v[20:23]
    s_waitcnt lgkmcnt(5)
    v_mfma_f32_16x16x32_bf16 v[20:23], v[168:171], v[72:75], v[20:23]
    s_waitcnt lgkmcnt(4)
    v_mfma_f32_16x16x32_bf16 v[20:23], v[172:175], v[76:79], v[20:23]
    s_waitcnt lgkmcnt(3)
    v_mfma_f32_16x16x32_bf16 v[20:23], v[176:179], v[80:83], v[20:23]
    s_waitcnt lgkmcnt(2)
    v_mfma_f32_16x16x32_bf16 v[20:23], v[180:183], v[84:87], v[20:23]
    s_waitcnt lgkmcnt(1)
    v_mfma_f32_16x16x32_bf16 v[20:23], v[184:187], v[88:91], v[20:23]
    s_waitcnt lgkmcnt(0)
    v_mfma_f32_16x16x32_bf16 v[20:23], v[188:191], v[92:95], v[20:23]
    s_nop 7
    v_max_f32 v24, v20, v21
    v_max3_f32 v24, v24, v22, v23
    v_mov_b32 v25, v24
    s_nop 1
    v_permlane16_swap_b32 v24, v25
    s_nop 1
    v_max_f32 v24, v24, v25
    v_mov_b32 v25, v24
    s_nop 1
    v_permlane32_swap_b32 v24, v25
    s_nop 1
    v_max_f32 v24, v24, v25
    ds_write_b32 v121, v24
    s_waitcnt lgkmcnt(0)
    s_barrier
    ds_read_b128 v[28:31], v120
    ds_read_b128 v[32:35], v120 offset:16
    s_waitcnt lgkmcnt(0)
    v_max3_f32 v28, v28, v29, v30
    v_max3_f32 v31, v31, v32, v33
    v_max3_f32 v28, v28, v34, v35
    v_max_f32 v28, v28, v31
    v_sub_f32 v20, v20, v28
    v_sub_f32 v21, v21, v28
    v_sub_f32 v22, v22, v28
    v_sub_f32 v23, v23, v28
    v_exp_f32 v20, v20
    v_exp_f32 v21, v21
    v_exp_f32 v22, v22
    v_exp_f32 v23, v23
    s_nop 0
    v_cvt_pk_bf16_f32 v24, v20, v21
    v_cvt_pk_bf16_f32 v25, v22, v23
    ds_write_b64 v122, v[24:25]
    v_add_f32 v20, v20, v21
    v_add_f32 v22, v22, v23
    v_add_f32 v20, v20, v22
    v_mov_b32 v21, v20
    s_nop 1
    v_permlane16_swap_b32 v20, v21
    s_nop 1
    v_add_f32 v20, v20, v21
    v_mov_b32 v21, v20
    s_nop 1
    v_permlane32_swap_b32 v20, v21
    s_nop 1
    v_add_f32 v20, v20, v21
    ds_write_b32 v121, v20 offset:2048
    s_waitcnt lgkmcnt(0)
    s_barrier
    ds_read_b128 v[32:35], v123 offset:0
    ds_read_b128 v[36:39], v123 offset:1024
    ds_read_b128 v[40:43], v123 offset:2048
    ds_read_b128 v[44:47], v123 offset:3072
    ds_read_b128 v[48:51], v120 offset:2048
    ds_read_b128 v[52:55], v120 offset:2064
    s_waitcnt lgkmcnt(5)
    v_mfma_f32_16x16x32_bf16 v[64:67], v[192:195], v[32:35], 0
    v_mfma_f32_16x16x32_bf16 v[68:71], v[208:211], v[32:35], 0
    v_mfma_f32_16x16x32_bf16 v[72:75], v[224:227], v[32:35], 0
    v_mfma_f32_16x16x32_bf16 v[76:79], v[240:243], v[32:35], 0
    s_waitcnt lgkmcnt(4)
    v_mfma_f32_16x16x32_bf16 v[64:67], v[196:199], v[36:39], v[64:67]
    v_mfma_f32_16x16x32_bf16 v[68:71], v[212:215], v[36:39], v[68:71]
    v_mfma_f32_16x16x32_bf16 v[72:75], v[228:231], v[36:39], v[72:75]
    v_mfma_f32_16x16x32_bf16 v[76:79], v[244:247], v[36:39], v[76:79]
    s_waitcnt lgkmcnt(3)
    v_mfma_f32_16x16x32_bf16 v[64:67], v[200:203], v[40:43], v[64:67]
    v_mfma_f32_16x16x32_bf16 v[68:71], v[216:219], v[40:43], v[68:71]
    v_mfma_f32_16x16x32_bf16 v[72:75], v[232:235], v[40:43], v[72:75]
    v_mfma_f32_16x16x32_bf16 v[76:79], v[248:251], v[40:43], v[76:79]
    s_waitcnt lgkmcnt(2)
    v_mfma_f32_16x16x32_bf16 v[64:67], v[204:207], v[44:47], v[64:67]
    v_mfma_f32_16x16x32_bf16 v[68:71], v[220:223], v[44:47], v[68:71]
    v_mfma_f32_16x16x32_bf16 v[72:75], v[236:239], v[44:47], v[72:75]
    v_mfma_f32_16x16x32_bf16 v[76:79], v[252:255], v[44:47], v[76:79]
    s_waitcnt lgkmcnt(0)
    v_add_f32 v48, v48, v49
    v_add_f32 v50, v50, v51
    v_add_f32 v52, v52, v53
    v_add_f32 v54, v54, v55
    v_add_f32 v48, v48, v50
    v_add_f32 v52, v52, v54
    v_add_f32 v48, v48, v52
    v_cvt_pk_bf16_f32 v49, v48, v48
    v_and_b32 v50, 0xffff0000, v49
    v_sub_f32 v50, v48, v50
    v_cvt_pk_bf16_f32 v29, v48, v50
    s_mov_b64 s[12:13], exec
    s_mov_b64 exec, 0xffff
    ds_write_b64 v124, v[28:29] offset:128
    s_mov_b64 exec, s[12:13]
    v_cvt_pk_bf16_f32 v80, v64, v65
    v_cvt_pk_bf16_f32 v81, v66, v67
    ds_write_b64 v124, v[80:81] offset:0
    v_cvt_pk_bf16_f32 v82, v68, v69
    v_cvt_pk_bf16_f32 v83, v70, v71
    ds_write_b64 v124, v[82:83] offset:32
    v_cvt_pk_bf16_f32 v84, v72, v73
    v_cvt_pk_bf16_f32 v85, v74, v75
    ds_write_b64 v124, v[84:85] offset:64
    v_cvt_pk_bf16_f32 v86, v76, v77
    v_cvt_pk_bf16_f32 v87, v78, v79
    ds_write_b64 v124, v[86:87] offset:96
    s_waitcnt lgkmcnt(0)
    s_barrier
    s_cmp_eq_u32 s4, 7
    s_cbranch_scc0 Ls4_22
    v_mov_b32 v28, s8
    v_mov_b32 v29, s8
    v_mov_b32 v30, s8
    v_mov_b32 v31, s8
    s_mov_b64 exec, 1
    global_store_dwordx4 v98, v[28:31], s[46:47] sc1
    s_mov_b64 exec, -1
Ls4_22:
    ds_read2_b32 v[32:33], v125 offset0:0 offset1:1
    ds_read_b32 v34, v125 offset:8
    v_mov_b32 v35, s8
    v_add_u32 v16, 6144, v125
    ds_read2_b32 v[36:37], v16 offset0:0 offset1:1
    ds_read_b32 v38, v16 offset:8
    v_mov_b32 v39, s8
    v_add_u32 v16, 12288, v125
    ds_read2_b32 v[40:41], v16 offset0:0 offset1:1
    ds_read_b32 v42, v16 offset:8
    v_mov_b32 v43, s8
    s_waitcnt lgkmcnt(4)
    global_store_dwordx4 v126, v[32:35], s[46:47] sc1
    s_waitcnt lgkmcnt(2)
    global_store_dwordx4 v127, v[36:39], s[46:47] sc1
    s_waitcnt lgkmcnt(0)
    global_store_dwordx4 v99, v[40:43], s[46:47] sc1
    s_barrier
    s_mov_b32 m0, s55
    s_nop 0
    global_load_lds_dwordx4 v5, s[26:27] nt
    s_mov_b32 m0, s56
    s_nop 0
    global_load_lds_dwordx4 v6, s[26:27] nt
    s_mov_b32 m0, s57
    s_nop 0
    global_load_lds_dwordx4 v7, s[26:27] nt
    s_mov_b32 m0, s58
    s_nop 0
    global_load_lds_dwordx4 v8, s[26:27] nt
    s_mov_b32 m0, s59
    s_nop 0
    global_load_lds_dwordx4 v9, s[26:27] nt
    s_lshl_b32 s9, s6, 9
    v_add_u32 v5, s9, v0
    v_lshlrev_b32 v5, 4, v5
    v_add_u32 v5, 8388608, v5
    v_add_u32 v6, 65536, v5
    v_add_u32 v7, 131072, v5
    v_add_u32 v8, 196608, v5
    v_lshlrev_b32 v9, 1, v0
    v_add_u32 v9, 156480, v9
    v_lshrrev_b32 v16, 2, v2
    v_and_b32 v17, 3, v2
    v_lshl_add_u32 v18, v3, 3, v16
    s_lshl_b32 s9, s4, 6
    v_add_u32 v18, s9, v18
    v_mul_u32_u24 v18, 80, v18
    v_lshl_add_u32 v18, v17, 3, v18
    v_add_u32 v10, 32768, v18
    v_and_b32 v16, 1, v2
    v_mul_u32_u24 v16, 1040, v16
    v_lshl_add_u32 v16, v3, 4, v16
    s_lshl_b32 s9, s4, 7
    s_add_u32 s9, s9, 156480
    v_add_u32 v11, s9, v16
    v_lshlrev_b32 v16, 6, v2
    s_lshl_b32 s9, s4, 2
    s_add_u32 s9, s9, 158592
    v_add_u32 v12, s9, v16
    v_lshrrev_b32 v16, 2, v1
    v_and_b32 v17, 3, v1
    v_mul_u32_u24 v18, 3, v16
    v_add_u32 v18, v18, v17
    v_min_u32 v18, 47, v18
    v_lshrrev_b32 v19, 1, v18
    v_and_b32 v18, 1, v18
    v_lshlrev_b32 v19, 7, v19
    v_lshl_add_u32 v19, v18, 5, v19
    v_add_u32 v13, 158592, v19
    s_lshl_b32 s9, s6, 4
    s_add_u32 s9, s9, s5
    s_mul_i32 s9, s9, 14
    v_add_u32 v16, s9, v16
    v_lshlrev_b32 v16, 4, v16
    v_add_u32 v14, 8650752, v16
    v_cmp_eq_u32 vcc, 0, v17
    v_cmp_gt_u32 s[10:11], 56, v1
    s_and_b64 s[62:63], vcc, s[10:11]
    s_waitcnt vmcnt(0)
    s_barrier
    ds_read_b64_tr_b16 v[64:65], v10 offset:0
    ds_read_b64_tr_b16 v[66:67], v10 offset:320
    ds_read_b64_tr_b16 v[68:69], v10 offset:32
    ds_read_b64_tr_b16 v[70:71], v10 offset:352
    ds_read_b64_tr_b16 v[72:73], v10 offset:64
    ds_read_b64_tr_b16 v[74:75], v10 offset:384
    ds_read_b64_tr_b16 v[76:77], v10 offset:2560
    ds_read_b64_tr_b16 v[78:79], v10 offset:2880
    ds_read_b64_tr_b16 v[80:81], v10 offset:2592
    ds_read_b64_tr_b16 v[82:83], v10 offset:2912
    ds_read_b64_tr_b16 v[84:85], v10 offset:2624
    ds_read_b64_tr_b16 v[86:87], v10 offset:2944
Lfg_23:
    global_load_dwordx4 v[16:19], v5, s[46:47] sc1
    global_load_dwordx4 v[20:23], v6, s[46:47] sc1
    global_load_dwordx4 v[24:27], v7, s[46:47] sc1
    global_load_dwordx4 v[28:31], v8, s[46:47] sc1
    s_waitcnt vmcnt(0)
    v_xor_b32 v40, s8, v19
    v_xor_b32 v41, s8, v23
    v_xor_b32 v27, s8, v27
    v_or3_b32 v40, v40, v41, v27
    v_xor_b32 v41, s8, v31
    v_or_b32 v40, v40, v41
    v_cmp_ne_u32 vcc, 0, v40
    s_cbranch_vccz Lok_24
    s_add_u32 s15, s15, 1
    s_cmp_lt_u32 s15, 200000
    s_cbranch_scc1 Lfg_23
Lok_24:
    v_add_f32 v16, v16, v20
    v_add_f32 v17, v17, v21
    v_add_f32 v24, v24, v28
    v_add_f32 v25, v25, v29
    v_add_f32 v16, v16, v24
    v_add_f32 v17, v17, v25
    v_cvt_pk_bf16_f32 v16, v16, v17
    ds_write_b16 v9, v16
    ds_write_b16_d16_hi v9, v16 offset:1040
    s_waitcnt lgkmcnt(0)
    s_barrier
    ds_read_b128 v[16:19], v11
    ds_read_b128 v[20:23], v11 offset:64
    s_waitcnt lgkmcnt(1)
    v_mfma_f32_16x16x32_bf16 v[32:35], v[16:19], v[64:67], 0
    v_mfma_f32_16x16x32_bf16 v[36:39], v[16:19], v[68:71], 0
    v_mfma_f32_16x16x32_bf16 v[40:43], v[16:19], v[72:75], 0
    s_waitcnt lgkmcnt(0)
    v_mfma_f32_16x16x32_bf16 v[32:35], v[20:23], v[76:79], v[32:35]
    v_mfma_f32_16x16x32_bf16 v[36:39], v[20:23], v[80:83], v[36:39]
    v_mfma_f32_16x16x32_bf16 v[40:43], v[20:23], v[84:87], v[40:43]
    s_mov_b64 s[12:13], exec
    s_mov_b64 exec, 0xffff
    s_nop 6
    ds_write_b32 v12, v32 offset:0
    ds_write_b32 v12, v33 offset:32
    ds_write_b32 v12, v36 offset:1024
    ds_write_b32 v12, v37 offset:1056
    ds_write_b32 v12, v40 offset:2048
    ds_write_b32 v12, v41 offset:2080
    s_mov_b64 exec, s[12:13]
    s_waitcnt lgkmcnt(0)
    s_barrier
    s_cmp_eq_u32 s4, 0
    s_cbranch_scc0 Lfd_25
    ds_read_b128 v[16:19], v13
    ds_read_b128 v[20:23], v13 offset:16
    ds_read_b128 v[24:27], v13 offset:64
    ds_read_b128 v[28:31], v13 offset:80
    v_mov_b32 v35, s8
    s_waitcnt lgkmcnt(2)
    v_add_f32 v16, v16, v17
    v_add_f32 v18, v18, v19
    v_add_f32 v20, v20, v21
    v_add_f32 v22, v22, v23
    v_add_f32 v16, v16, v18
    v_add_f32 v20, v20, v22
    v_add_f32 v16, v16, v20
    s_waitcnt lgkmcnt(0)
    v_add_f32 v24, v24, v25
    v_add_f32 v26, v26, v27
    v_add_f32 v28, v28, v29
    v_add_f32 v30, v30, v31
    v_add_f32 v24, v24, v26
    v_add_f32 v28, v28, v30
    v_add_f32 v24, v24, v28
    v_cvt_pk_bf16_f32 v32, v16, v24
    s_mov_b64 s[12:13], exec
    s_nop 0
    v_mov_b32_dpp v33, v32 quad_perm:[1,1,1,1] row_mask:0xf bank_mask:0xf
    v_mov_b32_dpp v34, v32 quad_perm:[2,2,2,2] row_mask:0xf bank_mask:0xf
    s_mov_b64 exec, s[62:63]
    global_store_dwordx4 v14, v[32:35], s[46:47] sc1
    s_mov_b64 exec, s[12:13]
Lfd_25:
    s_cmp_lt_u32 s5, 10
    s_cbranch_scc0 Lz_26
    s_cmp_eq_u32 s4, 0
    s_cbranch_scc0 Lz_26
    s_mul_i32 s48, s6, 10
    s_add_u32 s48, s48, s5
    v_and_b32 v16, 7, v1
    v_lshrrev_b32 v17, 3, v1
    s_lshl_b32 s9, s48, 3
    v_add_u32 v16, s9, v16
    v_lshlrev_b32 v18, 4, v16
    v_mul_u32_u24 v19, 10240, v17
    v_add_u32 v19, v19, v18
    v_add_u32 v5, 8781824, v19
    v_lshlrev_b32 v6, 3, v16
    v_add_u32 v6, 8716288, v6
    v_add_u32 v56, 5120, v6
    v_add_u32 v7, 34816, v18
    v_lshlrev_b32 v8, 1, v16
    global_load_ushort v9, v8, s[36:37]
    v_cmp_gt_u32 vcc, 6, v17
    s_mov_b64 s[56:57], vcc
    v_add_u32 v10, 81920, v5
    v_add_u32 v11, 163840, v5
    v_add_u32 v12, 245760, v5
    v_add_u32 v13, 327680, v5
    v_add_u32 v14, 409600, v5
    v_add_u32 v15, 491520, v5
Lz0_27:
    global_load_dwordx2 v[48:49], v6, s[46:47] sc1
    global_load_dwordx2 v[50:51], v56, s[46:47] sc1
    global_load_dwordx4 v[52:55], v7, s[46:47] sc1
    s_waitcnt vmcnt(0)
    v_xor_b32 v60, s8, v49
    v_xor_b32 v61, s8, v51
    v_xor_b32 v55, s8, v55
    v_or3_b32 v60, v60, v61, v55
    v_cmp_ne_u32 vcc, 0, v60
    s_cbranch_vccz Lok_28
    s_add_u32 s15, s15, 1
    s_cmp_lt_u32 s15, 200000
    s_cbranch_scc1 Lz0_27
Lok_28:
    v_mov_b32 v44, 0
    v_mov_b32 v45, 0
    v_mov_b32 v47, s8
    v_lshlrev_b32 v9, 16, v9
Lzg_29:
    global_load_dwordx4 v[20:23], v5, s[46:47] sc1
    global_load_dwordx4 v[24:27], v10, s[46:47] sc1
    global_load_dwordx4 v[28:31], v11, s[46:47] sc1
    global_load_dwordx4 v[32:35], v12, s[46:47] sc1
    global_load_dwordx4 v[36:39], v13, s[46:47] sc1
    global_load_dwordx4 v[40:43], v14, s[46:47] sc1
    s_mov_b64 s[12:13], exec
    s_mov_b64 exec, s[56:57]
    global_load_dwordx4 v[44:47], v15, s[46:47] sc1
    s_mov_b64 exec, s[12:13]
    s_waitcnt vmcnt(0)
    v_xor_b32 v60, s8, v23
    v_xor_b32 v61, s8, v27
    v_xor_b32 v31, s8, v31
    v_or3_b32 v60, v60, v61, v31
    v_xor_b32 v61, s8, v35
    v_xor_b32 v39, s8, v39
    v_or3_b32 v60, v60, v61, v39
    v_xor_b32 v61, s8, v43
    v_xor_b32 v47, s8, v47
    v_or3_b32 v60, v60, v61, v47
    v_cmp_ne_u32 vcc, 0, v60
    s_cbranch_vccz Lok_30
    s_add_u32 s15, s15, 1
    s_cmp_lt_u32 s15, 200000
    s_cbranch_scc1 Lzg_29
Lok_30:
    v_add_f32 v20, v20, v24
    v_add_f32 v28, v28, v32
    v_add_f32 v36, v36, v40
    v_add_f32 v21, v21, v25
    v_add_f32 v29, v29, v33
    v_add_f32 v37, v37, v41
    v_add_f32 v20, v20, v28
    v_add_f32 v36, v36, v44
    v_add_f32 v21, v21, v29
    v_add_f32 v37, v37, v45
    v_add_f32 v20, v20, v36
    v_add_f32 v21, v21, v37
    s_nop 1
    v_add_f32_dpp v20, v20, v20 row_ror:8 row_mask:0xf bank_mask:0xf
    v_add_f32_dpp v21, v21, v21 row_ror:8 row_mask:0xf bank_mask:0xf
    v_mov_b32 v22, v20
    v_mov_b32 v23, v21
    s_nop 1
    v_permlane16_swap_b32 v20, v22
    v_permlane16_swap_b32 v21, v23
    s_nop 1
    v_add_f32 v20, v20, v22
    v_add_f32 v21, v21, v23
    v_mov_b32 v22, v20
    v_mov_b32 v23, v21
    s_nop 1
    v_permlane32_swap_b32 v20, v22
    v_permlane32_swap_b32 v21, v23
    s_nop 1
    v_add_f32 v20, v20, v22
    v_add_f32 v21, v21, v23
    v_add_f32 v20, v20, v9
    v_add_f32 v21, v21, v9
    v_fma_f32 v20, v52, v20, v48
    v_fma_f32 v21, v53, v21, v50
    v_cvt_pk_bf16_f32 v20, v20, v21
    s_mov_b64 exec, 0xff
    global_store_short v8, v20, s[42:43]
    global_store_short_d16_hi v8, v20, s[42:43] offset:1280
    s_cmp_eq_u32 s48, 0
    s_cbranch_scc0 Lze_31
    v_mov_b32 v16, 0
    v_mov_b32 v17, s8
    s_mov_b64 exec, 1
    global_store_dword v16, v17, s[46:47] sc1
Lze_31:
    s_mov_b64 exec, -1
Lz_26:
    s_endpgm
L_setB:
    v_mov_b32 v249, 9437184
    v_mov_b32 v250, 9437184
    v_mov_b32 v251, 9437184
    v_mov_b32 v252, 9437184
    v_mov_b32 v199, 9437184
    v_mov_b32 v207, 9437184
    v_mov_b32 v215, 9437184
    v_mov_b32 v223, 9437184
    v_mov_b32 v246, 9437184
    s_lshl_b32 s48, s6, 2
    s_lshr_b32 s9, s5, 2
    s_add_u32 s48, s48, s9
    s_and_b32 s49, s5, 3
    s_lshl_b32 s50, s48, 8
    s_mul_i32 s51, s49, 160
    v_lshrrev_b32 v16, 4, v1
    s_bfe_u32 s9, s4, 0x10001
    s_lshl_b32 s9, s9, 2
    v_or_b32 v17, s9, v16
    v_lshrrev_b32 v18, 1, v2
    v_xor_b32 v18, v18, v17
    v_and_b32 v19, 1, v2
    v_lshl_or_b32 v18, v18, 1, v19
    s_lshl_b32 s10, s4, 2
    s_add_u32 s9, s51, s10
    v_add_u32 v19, s9, v16
    v_lshlrev_b32 v19, 13, v19
    v_lshl_add_u32 v18, v18, 4, s50
    v_add_u32 v20, v18, v19
    s_lshl_b32 s11, s4, 10
    s_add_u32 s11, s11, 0
    s_mov_b32 m0, s11
    s_add_u32 s11, s11, 8192
    global_load_lds_dwordx4 v20, s[20:21] nt
    v_add_u32 v20, 262144, v20
    s_mov_b32 m0, s11
    s_add_u32 s11, s11, 8192
    global_load_lds_dwordx4 v20, s[20:21] nt
    v_add_u32 v20, 262144, v20
    s_mov_b32 m0, s11
    s_add_u32 s11, s11, 8192
    global_load_lds_dwordx4 v20, s[20:21] nt
    v_add_u32 v20, 262144, v20
    s_mov_b32 m0, s11
    s_add_u32 s11, s11, 8192
    global_load_lds_dwordx4 v20, s[20:21] nt
    v_add_u32 v20, 262144, v20
    s_mov_b32 m0, s11
    s_nop 0
    global_load_lds_dwordx4 v20, s[20:21] nt
    v_lshrrev_b32 v16, 4, v1
    s_and_b32 s9, s4, 3
    s_lshl_b32 s9, s9, 2
    v_add_u32 v17, s9, v16
    v_xor_b32 v18, v2, v17
    s_lshl_b32 s9, s49, 7
    s_lshl_b32 s10, s4, 2
    s_add_u32 s9, s9, s10
    v_add_u32 v19, s9, v16
    v_lshlrev_b32 v19, 13, v19
    v_lshl_add_u32 v18, v18, 4, s50
    v_add_u32 v20, v18, v19
    s_lshl_b32 s11, s4, 10
    s_add_u32 s11, s11, 40960
    s_mov_b32 m0, s11
    s_add_u32 s11, s11, 8192
    global_load_lds_dwordx4 v20, s[22:23] nt
    v_add_u32 v20, 262144, v20
    s_mov_b32 m0, s11
    s_add_u32 s11, s11, 8192
    global_load_lds_dwordx4 v20, s[22:23] nt
    v_add_u32 v20, 262144, v20
    s_mov_b32 m0, s11
    s_add_u32 s11, s11, 8192
    global_load_lds_dwordx4 v20, s[22:23] nt
    v_add_u32 v20, 262144, v20
    s_mov_b32 m0, s11
    s_nop 0
    global_load_lds_dwordx4 v20, s[22:23] nt
    s_waitcnt lgkmcnt(0)
    s_mul_i32 s8, s7, 1664525
    s_add_u32 s8, s8, 1013904223
    s_and_b32 s8, s8, 0xBFFFBFFF
    s_cmp_eq_u32 s8, s7
    s_cbranch_scc0 Ltag_32
    s_xor_b32 s8, s8, 1
Ltag_32:
    v_add_u32 v5, s51, v0
    v_lshlrev_b32 v5, 4, v5
    v_add_u32 v5, 65536, v5
    v_lshlrev_b32 v6, 1, v0
    v_add_u32 v6, 114688, v6
    v_lshrrev_b32 v16, 2, v2
    v_and_b32 v17, 3, v2
    v_and_b32 v18, 1, v3
    v_lshl_or_b32 v18, v18, 2, v16
    v_xor_b32 v18, s4, v18
    v_lshl_add_u32 v19, v3, 3, v16
    v_lshlrev_b32 v19, 8, v19
    v_lshl_add_u32 v19, v18, 5, v19
    v_lshl_add_u32 v19, v17, 3, v19
    v_add_u32 v7, 0, v19
    v_and_b32 v20, 1, v2
    v_mul_u32_u24 v21, 320, v20
    v_lshl_add_u32 v21, v3, 4, v21
    v_add_u32 v8, 114688, v21
    s_lshl_b32 s9, s49, 5
    s_add_u32 s9, s9, s48
    s_lshl_b32 s9, s9, 7
    s_lshl_b32 s10, s4, 4
    s_add_u32 s9, s9, s10
    v_add_u32 v9, s9, v2
    v_lshlrev_b32 v9, 4, v9
    v_add_u32 v9, 131072, v9
    s_lshl_b32 s9, s48, 7
    v_add_u32 v10, s9, v0
    v_lshlrev_b32 v10, 4, v10
    v_add_u32 v10, 131072, v10
    v_lshlrev_b32 v11, 1, v0
    v_add_u32 v11, 115328, v11
    s_lshl_b32 s9, s4, 4
    v_add_u32 v12, s9, v2
    v_lshlrev_b32 v12, 8, v12
    v_add_u32 v12, 40960, v12
    v_xor_b32 v13, v3, v2
    v_lshlrev_b32 v13, 4, v13
    v_add_u32 v41, 10240, v5
    v_add_u32 v42, 20480, v5
    v_add_u32 v43, 30720, v5
    v_add_u32 v44, 40960, v5
    v_add_u32 v45, 65536, v10
    v_add_u32 v46, 131072, v10
    v_add_u32 v47, 196608, v10
    v_and_b32 v20, 1, v2
    v_lshlrev_b32 v20, 8, v20
    v_lshl_add_u32 v20, v3, 4, v20
    v_add_u32 v48, 115328, v20
    v_mul_u32_u24 v21, 272, v2
    v_lshl_add_u32 v21, v3, 3, v21
    s_lshl_b32 s9, s4, 5
    s_add_u32 s9, s9, 115840
    v_add_u32 v49, s9, v21
    v_cmp_lt_u32 vcc, 21, v1
    v_subrev_u32 v16, 22, v1
    s_nop 0
    v_cndmask_b32 v16, v1, v16, vcc
    v_cndmask_b32 v17, 0, 1, vcc
    v_mul_u32_u24 v18, 272, v17
    v_mul_u32_u24 v19, 12, v16
    v_add_u32 v18, v18, v19
    v_add_u32 v50, 115840, v18
    v_lshlrev_b32 v19, 7, v17
    s_lshl_b32 s9, s48, 2
    s_add_u32 s9, s9, s49
    v_add_u32 v19, s9, v19
    v_mul_u32_u24 v19, 22, v19
    v_add_u32 v19, v19, v16
    v_lshlrev_b32 v19, 4, v19
    v_add_u32 v51, 393216, v19
    s_lshl_b32 s9, s4, 4
    v_add_u32 v16, s9, v2
    v_lshlrev_b32 v16, 3, v16
    v_add_u32 v52, 146080, v16
    v_and_b32 v16, 127, v0
    v_lshlrev_b32 v17, 3, v16
    v_add_u32 v53, 146080, v17
    s_lshl_b32 s9, s49, 5
    s_add_u32 s9, s9, s48
    s_lshl_b32 s9, s9, 7
    v_add_u32 v16, s9, v16
    v_lshlrev_b32 v16, 4, v16
    v_add_u32 v9, 131072, v16
    s_cmp_lt_u32 s4, 3
    s_cbranch_scc0 Lp2b_34
    v_cmp_gt_u32 vcc, 160, v0
    s_and_saveexec_b64 s[12:13], vcc
Lp2g_33:
    global_load_dwordx4 v[16:19], v5, s[46:47] sc1
    global_load_dwordx4 v[20:23], v41, s[46:47] sc1
    global_load_dwordx4 v[24:27], v42, s[46:47] sc1
    global_load_dwordx4 v[28:31], v43, s[46:47] sc1
    global_load_dwordx4 v[32:35], v44, s[46:47] sc1
    s_waitcnt vmcnt(0)
    v_xor_b32 v36, s8, v19
    v_xor_b32 v37, s8, v23
    v_xor_b32 v27, s8, v27
    v_or3_b32 v36, v36, v37, v27
    v_xor_b32 v37, s8, v31
    v_xor_b32 v35, s8, v35
    v_or3_b32 v36, v36, v37, v35
    v_cmp_ne_u32 vcc, 0, v36
    s_cbranch_vccz Lok_35
    s_add_u32 s15, s15, 1
    s_cmp_lt_u32 s15, 200000
    s_cbranch_scc1 Lp2g_33
Lok_35:
    v_add_f32 v16, v16, v20
    v_add_f32 v17, v17, v21
    v_add_f32 v24, v24, v28
    v_add_f32 v25, v25, v29
    v_add_f32 v16, v16, v32
    v_add_f32 v17, v17, v33
    v_add_f32 v16, v16, v24
    v_add_f32 v17, v17, v25
    v_cvt_pk_bf16_f32 v16, v16, v17
    ds_write_b16 v6, v16
    ds_write_b16_d16_hi v6, v16 offset:320
    s_mov_b64 exec, s[12:13]
Lp2b_34:
    s_waitcnt vmcnt(0) lgkmcnt(0)
    s_barrier
    ds_read_b128 v[16:19], v8 offset:0
    ds_read_b64_tr_b16 v[64:65], v7 offset:0
    ds_read_b64_tr_b16 v[66:67], v7 offset:1024
    ds_read_b128 v[20:23], v8 offset:64
    ds_read_b64_tr_b16 v[68:69], v7 offset:8192
    ds_read_b64_tr_b16 v[70:71], v7 offset:9216
    ds_read_b128 v[24:27], v8 offset:128
    ds_read_b64_tr_b16 v[72:73], v7 offset:16384
    ds_read_b64_tr_b16 v[74:75], v7 offset:17408
    ds_read_b128 v[28:31], v8 offset:192
    ds_read_b64_tr_b16 v[76:77], v7 offset:24576
    ds_read_b64_tr_b16 v[78:79], v7 offset:25600
    ds_read_b128 v[32:35], v8 offset:256
    ds_read_b64_tr_b16 v[80:81], v7 offset:32768
    ds_read_b64_tr_b16 v[82:83], v7 offset:33792
    v_mov_b32 v62, 0
    v_mov_b32 v63, s8
    s_waitcnt lgkmcnt(12)
    v_mfma_f32_16x16x32_bf16 v[56:59], v[16:19], v[64:67], 0
    s_waitcnt lgkmcnt(9)
    v_mfma_f32_16x16x32_bf16 v[56:59], v[20:23], v[68:71], v[56:59]
    s_waitcnt lgkmcnt(6)
    v_mfma_f32_16x16x32_bf16 v[56:59], v[24:27], v[72:75], v[56:59]
    s_waitcnt lgkmcnt(3)
    v_mfma_f32_16x16x32_bf16 v[56:59], v[28:31], v[76:79], v[56:59]
    s_waitcnt lgkmcnt(0)
    v_mfma_f32_16x16x32_bf16 v[56:59], v[32:35], v[80:83], v[56:59]
    v_xor_b32 v36, 0, v13
    v_add_u32 v36, v36, v12
    ds_read_b128 v[84:87], v36
    v_xor_b32 v36, 64, v13
    v_add_u32 v36, v36, v12
    ds_read_b128 v[88:91], v36
    v_xor_b32 v36, 128, v13
    v_add_u32 v36, v36, v12
    ds_read_b128 v[92:95], v36
    v_xor_b32 v36, 192, v13
    v_add_u32 v36, v36, v12
    ds_read_b128 v[96:99], v36
    s_mov_b64 exec, 0xffff
    ds_write_b64 v52, v[56:57]
    s_mov_b64 exec, -1
    s_waitcnt lgkmcnt(0)
    s_barrier
    s_and_b32 s9, s4, 6
    s_cmp_eq_u32 s9, 4
    s_cbranch_scc0 Lp2p_36
    ds_read_b64 v[60:61], v53
    s_waitcnt lgkmcnt(0)
    global_store_dwordx4 v9, v[60:63], s[46:47] sc1
Lp2p_36:
    s_cmp_lt_u32 s4, 2
    s_cbranch_scc0 Lp3b_38
Lp3g_37:
    global_load_dwordx4 v[16:19], v10, s[46:47] sc1
    global_load_dwordx4 v[20:23], v45, s[46:47] sc1
    global_load_dwordx4 v[24:27], v46, s[46:47] sc1
    global_load_dwordx4 v[28:31], v47, s[46:47] sc1
    s_waitcnt vmcnt(0)
    v_xor_b32 v36, s8, v19
    v_xor_b32 v37, s8, v23
    v_xor_b32 v27, s8, v27
    v_or3_b32 v36, v36, v37, v27
    v_xor_b32 v37, s8, v31
    v_or_b32 v36, v36, v37
    v_cmp_ne_u32 vcc, 0, v36
    s_cbranch_vccz Lok_39
    s_add_u32 s15, s15, 1
    s_cmp_lt_u32 s15, 200000
    s_cbranch_scc1 Lp3g_37
Lok_39:
    v_add_f32 v16, v16, v20
    v_add_f32 v17, v17, v21
    v_add_f32 v24, v24, v28
    v_add_f32 v25, v25, v29
    v_add_f32 v16, v16, v24
    v_add_f32 v17, v17, v25
    v_cvt_pk_bf16_f32 v16, v16, v17
    ds_write_b16 v11, v16
    ds_write_b16_d16_hi v11, v16 offset:256
Lp3b_38:
    s_waitcnt lgkmcnt(0)
    s_barrier
    ds_read_b128 v[24:27], v48 offset:0
    ds_read_b128 v[28:31], v48 offset:64
    ds_read_b128 v[32:35], v48 offset:128
    ds_read_b128 v[36:39], v48 offset:192
    s_mov_b32 s9, 0x3e0293ee
    v_cmp_gt_u32 vcc, 2, v2
    s_waitcnt lgkmcnt(3)
    v_mfma_f32_16x16x32_bf16 v[40:43], v[84:87], v[24:27], 0
    s_waitcnt lgkmcnt(2)
    v_mfma_f32_16x16x32_bf16 v[40:43], v[88:91], v[28:31], v[40:43]
    s_waitcnt lgkmcnt(1)
    v_mfma_f32_16x16x32_bf16 v[40:43], v[92:95], v[32:35], v[40:43]
    s_waitcnt lgkmcnt(0)
    v_mfma_f32_16x16x32_bf16 v[40:43], v[96:99], v[36:39], v[40:43]
    s_and_saveexec_b64 s[12:13], vcc
    s_nop 6
    v_mul_f32 v40, s9, v40
    v_mul_f32 v41, s9, v41
    v_mul_f32 v42, s9, v42
    v_mul_f32 v43, s9, v43
    v_cvt_pk_bf16_f32 v44, v40, v41
    v_cvt_pk_bf16_f32 v45, v42, v43
    ds_write_b64 v49, v[44:45]
    s_mov_b64 exec, s[12:13]
    s_waitcnt lgkmcnt(0)
    s_barrier
    s_cmp_eq_u32 s4, 0
    s_cbranch_scc0 Lp3d_40
    ds_read2_b32 v[40:41], v50 offset0:0 offset1:1
    ds_read_b32 v42, v50 offset:8
    v_mov_b32 v43, s8
    s_mov_b32 exec_hi, 0xfff
    s_waitcnt lgkmcnt(0)
    global_store_dwordx4 v51, v[40:43], s[46:47] sc1
    s_mov_b64 exec, -1
Lp3d_40:
    s_barrier
    s_lshl_b32 s51, s49, 7
    v_lshrrev_b32 v16, 4, v1
    s_bfe_u32 s9, s4, 0x10001
    s_lshl_b32 s9, s9, 2
    v_or_b32 v17, s9, v16
    v_lshrrev_b32 v18, 1, v2
    v_xor_b32 v18, v18, v17
    v_and_b32 v19, 1, v2
    v_lshl_or_b32 v18, v18, 1, v19
    s_lshl_b32 s10, s4, 2
    s_add_u32 s9, s51, s10
    v_add_u32 v19, s9, v16
    v_lshlrev_b32 v19, 13, v19
    v_lshl_add_u32 v18, v18, 4, s50
    v_add_u32 v20, v18, v19
    s_lshl_b32 s11, s4, 10
    s_add_u32 s11, s11, 81920
    s_mov_b32 m0, s11
    s_add_u32 s11, s11, 8192
    global_load_lds_dwordx4 v20, s[24:25] nt
    v_add_u32 v20, 262144, v20
    s_mov_b32 m0, s11
    s_add_u32 s11, s11, 8192
    global_load_lds_dwordx4 v20, s[24:25] nt
    v_add_u32 v20, 262144, v20
    s_mov_b32 m0, s11
    s_add_u32 s11, s11, 8192
    global_load_lds_dwordx4 v20, s[24:25] nt
    v_add_u32 v20, 262144, v20
    s_mov_b32 m0, s11
    s_nop 0
    global_load_lds_dwordx4 v20, s[24:25] nt
    s_cmp_ge_u32 s5, 7
    s_cbranch_scc1 Lb2m_41
    s_mul_i32 s52, s6, 7
    s_add_u32 s52, s52, s5
    s_cmp_lt_u32 s52, 54
    s_cbranch_scc0 Lb2e_42
    s_lshl_b32 s13, s52, 6
    v_lshrrev_b32 v44, 2, v1
    v_and_b32 v45, 3, v1
    v_lshrrev_b32 v46, 1, v45
    v_lshrrev_b32 v47, 5, v1
    v_xor_b32 v46, v46, v47
    v_and_b32 v45, 1, v45
    v_lshl_or_b32 v46, v46, 1, v45
    s_lshl_b32 s9, s4, 4
    v_add_u32 v44, s9, v44
    v_mul_u32_u24 v44, 3456, v44
    v_lshl_add_u32 v44, v46, 4, v44
    v_add_u32 v44, s13, v44
    s_lshl_b32 s11, s4, 10
    s_add_u32 s11, s11, 0
    s_mov_b32 m0, s11
    s_add_u32 s11, s11, 8192
    global_load_lds_dwordx4 v44, s[30:31] nt
    v_add_u32 v44, 442368, v44
    s_mov_b32 m0, s11
    s_add_u32 s11, s11, 8192
    global_load_lds_dwordx4 v44, s[30:31] nt
    v_add_u32 v44, 442368, v44
    s_mov_b32 m0, s11
    s_add_u32 s11, s11, 8192
    global_load_lds_dwordx4 v44, s[30:31] nt
    v_add_u32 v44, 442368, v44
    s_mov_b32 m0, s11
    s_add_u32 s11, s11, 8192
    global_load_lds_dwordx4 v44, s[30:31] nt
    v_add_u32 v44, 442368, v44
    s_mov_b32 m0, s11
    s_add_u32 s11, s11, 8192
    global_load_lds_dwordx4 v44, s[30:31] nt
    s_branch Lb2e_42
Lb2m_41:
    s_mul_i32 s52, s6, 9
    s_add_u32 s52, s52, s5
    s_sub_u32 s52, s52, 7
    s_lshl_b32 s13, s52, 6
    s_add_u32 s13, s13, 2560
    v_lshrrev_b32 v44, 2, v1
    v_and_b32 v45, 3, v1
    v_lshrrev_b32 v46, 1, v45
    v_lshrrev_b32 v47, 5, v1
    v_xor_b32 v46, v46, v47
    v_and_b32 v45, 1, v45
    v_lshl_or_b32 v46, v46, 1, v45
    s_lshl_b32 s9, s4, 4
    v_add_u32 v44, s9, v44
    v_mul_u32_u24 v44, 7680, v44
    v_lshl_add_u32 v44, v46, 4, v44
    v_add_u32 v44, s13, v44
    s_lshl_b32 s11, s4, 10
    s_add_u32 s11, s11, 0
    s_mov_b32 m0, s11
    s_add_u32 s11, s11, 8192
    global_load_lds_dwordx4 v44, s[40:41] nt
    v_add_u32 v44, 983040, v44
    s_mov_b32 m0, s11
    s_add_u32 s11, s11, 8192
    global_load_lds_dwordx4 v44, s[40:41] nt
    v_add_u32 v44, 983040, v44
    s_mov_b32 m0, s11
    s_add_u32 s11, s11, 8192
    global_load_lds_dwordx4 v44, s[40:41] nt
    v_add_u32 v44, 983040, v44
    s_mov_b32 m0, s11
    s_add_u32 s11, s11, 8192
    global_load_lds_dwordx4 v44, s[40:41] nt
    v_add_u32 v44, 983040, v44
    s_mov_b32 m0, s11
    s_add_u32 s11, s11, 8192
    global_load_lds_dwordx4 v44, s[40:41] nt
Lb2e_42:
    s_cmp_lt_u32 s5, 7
    s_cbranch_scc0 Lge_43
    s_cmp_lt_u32 s52, 54
    s_cbranch_scc0 Lge_43
    s_add_u32 s9, s4, 0
    s_lshl_b32 s9, s9, 4
    v_add_u32 v16, s9, v2
    v_min_u32 v16, 223, v16
    v_mul_u32_u24 v17, 224, v3
    v_add_u32 v17, v17, v16
    v_lshlrev_b32 v17, 4, v17
    v_add_u32 v249, 8650752, v17
    v_add_u32 v250, 14336, v249
    s_mov_b32 s10, 74899
    v_mul_u32_u24 v17, s10, v16
    v_lshrrev_b32 v17, 20, v17
    v_mul_u32_u24 v18, 14, v17
    v_sub_u32 v18, v16, v18
    v_mul_u32_u24 v18, 3, v18
    v_mul_u32_u24 v17, 40, v17
    v_lshl_add_u32 v18, v3, 1, v18
    v_add_u32 v19, 0, v18
    v_lshrrev_b32 v20, 1, v19
    v_and_b32 v21, 1, v19
    v_lshl_add_u32 v20, v20, 1, v17
    v_cmp_gt_u32 vcc, 40, v19
    v_cmp_gt_u32 s[10:11], 2, v3
    s_and_b64 s[10:11], s[10:11], vcc
    s_nop 0
    v_cndmask_b32 v20, 0, v20, s[10:11]
    v_mul_u32_u24 v22, 1280, v21
    v_lshl_add_u32 v22, v20, 1, v22
    global_load_dword v193, v22, s[16:17]
    v_mul_u32_u24 v22, 2560, v21
    v_lshl_add_u32 v22, v20, 2, v22
    v_add_u32 v230, 117568, v22
    v_mul_u32_u24 v22, 1296, v21
    v_lshl_add_u32 v22, v20, 1, v22
    v_add_u32 v22, 132992, v22
    v_mov_b32 v23, 146016
    v_cndmask_b32 v198, v23, v22, s[10:11]
    v_mul_u32_u24 v22, 640, v21
    v_add_u32 v22, v22, v20
    v_lshlrev_b32 v22, 3, v22
    v_add_u32 v22, 8716288, v22
    v_mov_b32 v23, 9437184
    v_cndmask_b32 v199, v23, v22, s[10:11]
    v_add_u32 v19, 1, v18
    v_lshrrev_b32 v20, 1, v19
    v_and_b32 v21, 1, v19
    v_lshl_add_u32 v20, v20, 1, v17
    v_cmp_gt_u32 vcc, 40, v19
    v_cmp_gt_u32 s[10:11], 1, v3
    s_and_b64 s[10:11], s[10:11], vcc
    s_nop 0
    v_cndmask_b32 v20, 0, v20, s[10:11]
    v_mul_u32_u24 v22, 1280, v21
    v_lshl_add_u32 v22, v20, 1, v22
    global_load_dword v201, v22, s[16:17]
    v_mul_u32_u24 v22, 2560, v21
    v_lshl_add_u32 v22, v20, 2, v22
    v_add_u32 v231, 117568, v22
    v_mul_u32_u24 v22, 1296, v21
    v_lshl_add_u32 v22, v20, 1, v22
    v_add_u32 v22, 132992, v22
    v_mov_b32 v23, 146016
    v_cndmask_b32 v206, v23, v22, s[10:11]
    v_mul_u32_u24 v22, 640, v21
    v_add_u32 v22, v22, v20
    v_lshlrev_b32 v22, 3, v22
    v_add_u32 v22, 8716288, v22
    v_mov_b32 v23, 9437184
    v_cndmask_b32 v207, v23, v22, s[10:11]
    s_add_u32 s9, s4, 8
    s_lshl_b32 s9, s9, 4
    v_add_u32 v16, s9, v2
    v_min_u32 v16, 223, v16
    v_mul_u32_u24 v17, 224, v3
    v_add_u32 v17, v17, v16
    v_lshlrev_b32 v17, 4, v17
    v_add_u32 v251, 8650752, v17
    v_add_u32 v252, 14336, v251
    s_mov_b32 s10, 74899
    v_mul_u32_u24 v17, s10, v16
    v_lshrrev_b32 v17, 20, v17
    v_mul_u32_u24 v18, 14, v17
    v_sub_u32 v18, v16, v18
    v_mul_u32_u24 v18, 3, v18
    v_mul_u32_u24 v17, 40, v17
    v_lshl_add_u32 v18, v3, 1, v18
    v_add_u32 v19, 0, v18
    v_lshrrev_b32 v20, 1, v19
    v_and_b32 v21, 1, v19
    v_lshl_add_u32 v20, v20, 1, v17
    v_cmp_gt_u32 vcc, 40, v19
    v_cmp_gt_u32 s[10:11], 2, v3
    s_and_b64 s[10:11], s[10:11], vcc
    s_nop 0
    v_cndmask_b32 v20, 0, v20, s[10:11]
    v_mul_u32_u24 v22, 1280, v21
    v_lshl_add_u32 v22, v20, 1, v22
    global_load_dword v209, v22, s[16:17]
    v_mul_u32_u24 v22, 2560, v21
    v_lshl_add_u32 v22, v20, 2, v22
    v_add_u32 v232, 117568, v22
    v_mul_u32_u24 v22, 1296, v21
    v_lshl_add_u32 v22, v20, 1, v22
    v_add_u32 v22, 132992, v22
    v_mov_b32 v23, 146016
    v_cndmask_b32 v214, v23, v22, s[10:11]
    v_mul_u32_u24 v22, 640, v21
    v_add_u32 v22, v22, v20
    v_lshlrev_b32 v22, 3, v22
    v_add_u32 v22, 8716288, v22
    v_mov_b32 v23, 9437184
    v_cndmask_b32 v215, v23, v22, s[10:11]
    v_add_u32 v19, 1, v18
    v_lshrrev_b32 v20, 1, v19
    v_and_b32 v21, 1, v19
    v_lshl_add_u32 v20, v20, 1, v17
    v_cmp_gt_u32 vcc, 40, v19
    v_cmp_gt_u32 s[10:11], 1, v3
    s_and_b64 s[10:11], s[10:11], vcc
    s_nop 0
    v_cndmask_b32 v20, 0, v20, s[10:11]
    v_mul_u32_u24 v22, 1280, v21
    v_lshl_add_u32 v22, v20, 1, v22
    global_load_dword v217, v22, s[16:17]
    v_mul_u32_u24 v22, 2560, v21
    v_lshl_add_u32 v22, v20, 2, v22
    v_add_u32 v233, 117568, v22
    v_mul_u32_u24 v22, 1296, v21
    v_lshl_add_u32 v22, v20, 1, v22
    v_add_u32 v22, 132992, v22
    v_mov_b32 v23, 146016
    v_cndmask_b32 v222, v23, v22, s[10:11]
    v_mul_u32_u24 v22, 640, v21
    v_add_u32 v22, v22, v20
    v_lshlrev_b32 v22, 3, v22
    v_add_u32 v22, 8716288, v22
    v_mov_b32 v23, 9437184
    v_cndmask_b32 v223, v23, v22, s[10:11]
    v_and_b32 v16, 31, v1
    s_lshl_b32 s9, s52, 5
    v_add_u32 v16, s9, v16
    v_lshlrev_b32 v16, 1, v16
    global_load_ushort v234, v16, s[32:33]
    v_and_b32 v16, 3, v2
    v_mul_u32_u24 v16, 1296, v16
    v_lshl_add_u32 v16, v3, 4, v16
    s_lshl_b32 s9, s4, 6
    s_add_u32 s10, s9, 127808
    v_add_u32 v226, s10, v16
    v_min_u32 v16, 5, v2
    v_mul_u32_u24 v16, 1296, v16
    v_lshl_add_u32 v16, v3, 4, v16
    s_add_u32 s10, s9, 132992
    v_add_u32 v227, s10, v16
    v_lshlrev_b32 v16, 7, v2
    s_lshl_b32 s9, s4, 2
    s_add_u32 s10, s9, 140768
    v_add_u32 v228, s10, v16
    v_and_b32 v16, 31, v1
    v_lshrrev_b32 v17, 5, v1
    v_lshlrev_b32 v16, 7, v16
    v_lshl_add_u32 v16, v17, 5, v16
    v_add_u32 v229, 140768, v16
    v_lshrrev_b32 v16, 1, v2
    v_and_b32 v17, 1, v2
    v_lshlrev_b32 v17, 4, v17
    v_mov_b32 v18, 0x3f80
    v_lshlrev_b32 v18, v17, v18
    v_cmp_eq_u32 vcc, 0, v16
    s_nop 1
    v_cndmask_b32 v236, 0, v18, vcc
    v_cmp_eq_u32 vcc, 1, v16
    s_nop 1
    v_cndmask_b32 v237, 0, v18, vcc
    v_cmp_eq_u32 vcc, 2, v16
    s_nop 1
    v_cndmask_b32 v238, 0, v18, vcc
    v_cmp_eq_u32 vcc, 3, v16
    s_nop 1
    v_cndmask_b32 v239, 0, v18, vcc
    v_cmp_gt_u32 vcc, 6, v2
    s_nop 1
    v_cndmask_b32 v236, 0, v236, vcc
    v_mov_b32 v240, 0x3f803f80
    v_cndmask_b32 v237, 0, v237, vcc
    v_mov_b32 v241, 0x3f803f80
    v_cndmask_b32 v238, 0, v238, vcc
    v_mov_b32 v242, 0x3f803f80
    v_cndmask_b32 v239, 0, v239, vcc
    v_mov_b32 v243, 0x3f803f80
    s_lshl_b32 s9, s4, 2
    s_add_u32 s9, s9, 144864
    v_mov_b32 v247, s9
    v_lshrrev_b32 v16, 5, v1
    v_lshlrev_b32 v16, 5, v16
    v_add_u32 v248, 144864, v16
    s_lshl_b32 s9, s4, 7
    s_add_u32 s9, s9, 144992
    v_lshl_add_u32 v244, v1, 1, s9
    v_and_b32 v16, 1, v2
    v_lshlrev_b32 v16, 6, v16
    v_lshl_add_u32 v16, v3, 4, v16
    v_add_u32 v245, s9, v16
    s_mul_i32 s9, s52, 640
    s_mul_i32 s10, s4, 80
    s_add_u32 s9, s9, s10
    v_add_u32 v16, s9, v1
    v_lshlrev_b32 v16, 4, v16
    v_add_u32 v246, 8781824, v16
Lge_43:
    s_cmp_ge_u32 s5, 7
    s_cbranch_scc0 Lm2_44
    v_cmp_gt_u32 vcc, 320, v0
    s_and_saveexec_b64 s[12:13], vcc
    s_cbranch_execz Lm2s_45
    v_lshlrev_b32 v16, 2, v0
    global_load_dword v18, v16, s[38:39]
    global_load_dword v19, v16, s[38:39] offset:1280
    s_waitcnt vmcnt(0)
    v_lshlrev_b32 v20, 16, v18
    v_and_b32 v21, 0xffff0000, v18
    v_mul_f32 v22, 0xbfb8aa3b, v20
    v_mul_f32 v23, 0xbfb8aa3b, v21
    v_exp_f32 v22, v22
    v_exp_f32 v23, v23
    s_nop 0
    v_add_f32 v22, 1.0, v22
    v_add_f32 v23, 1.0, v23
    v_rcp_f32 v22, v22
    v_rcp_f32 v23, v23
    s_nop 0
    v_mul_f32 v20, v20, v22
    v_mul_f32 v21, v21, v23
    v_cvt_pk_bf16_f32 v24, v20, v21
    v_lshlrev_b32 v20, 16, v19
    v_and_b32 v21, 0xffff0000, v19
    v_mul_f32 v22, 0xbfb8aa3b, v20
    v_mul_f32 v23, 0xbfb8aa3b, v21
    v_exp_f32 v22, v22
    v_exp_f32 v23, v23
    s_nop 0
    v_add_f32 v22, 1.0, v22
    v_add_f32 v23, 1.0, v23
    v_rcp_f32 v22, v22
    v_rcp_f32 v23, v23
    s_nop 0
    v_mul_f32 v20, v20, v22
    v_mul_f32 v21, v21, v23
    v_cvt_pk_bf16_f32 v25, v20, v21
    v_add_u32 v16, 147104, v16
    ds_write_b32 v16, v24
    ds_write_b32 v16, v25 offset:1296
Lm2s_45:
    s_mov_b64 exec, s[12:13]
    v_lshrrev_b32 v16, 2, v2
    v_and_b32 v17, 3, v2
    v_lshl_add_u32 v18, v3, 3, v16
    v_lshlrev_b32 v18, 6, v18
    v_lshl_add_u32 v18, v17, 3, v18
    s_lshl_b32 s9, s4, 11
    s_add_u32 s9, s9, 0
    v_add_u32 v18, s9, v18
    v_and_b32 v19, 1, v3
    v_lshl_add_u32 v26, v19, 5, v18
    v_xor_b32 v19, 1, v19
    v_lshl_add_u32 v27, v19, 5, v18
    v_and_b32 v16, 1, v2
    v_mul_u32_u24 v16, 1296, v16
    v_lshl_add_u32 v16, v3, 4, v16
    s_lshl_b32 s9, s4, 6
    s_add_u32 s9, s9, 147104
    v_add_u32 v28, s9, v16
    v_lshlrev_b32 v16, 6, v2
    s_lshl_b32 s9, s4, 2
    s_add_u32 s9, s9, 140768
    v_add_u32 v29, s9, v16
    v_lshlrev_b32 v16, 6, v1
    v_add_u32 v30, 140768, v16
    s_lshl_b32 s9, s52, 5
    v_add_u32 v16, s9, v1
    v_lshlrev_b32 v16, 4, v16
    v_add_u32 v31, 4096, v16
    s_waitcnt vmcnt(0) lgkmcnt(0)
    s_barrier
    ds_read_b64_tr_b16 v[64:65], v26 offset:0
    ds_read_b64_tr_b16 v[66:67], v26 offset:256
    ds_read_b64_tr_b16 v[68:69], v27 offset:0
    ds_read_b64_tr_b16 v[70:71], v27 offset:256
    ds_read_b64_tr_b16 v[72:73], v26 offset:16384
    ds_read_b64_tr_b16 v[74:75], v26 offset:16640
    ds_read_b64_tr_b16 v[76:77], v27 offset:16384
    ds_read_b64_tr_b16 v[78:79], v27 offset:16640
    s_cmp_lt_u32 s4, 4
    s_cbranch_scc0 Lt3_46
    ds_read_b64_tr_b16 v[80:81], v26 offset:32768
    ds_read_b64_tr_b16 v[82:83], v26 offset:33024
    ds_read_b64_tr_b16 v[84:85], v27 offset:32768
    ds_read_b64_tr_b16 v[86:87], v27 offset:33024
Lt3_46:
    ds_read_b128 v[32:35], v28
    ds_read_b128 v[36:39], v28 offset:512
    s_cmp_lt_u32 s4, 4
    s_cbranch_scc0 Lm3_47
    ds_read_b128 v[40:43], v28 offset:1024
    s_waitcnt lgkmcnt(0)
    v_mfma_f32_16x16x32_bf16 v[48:51], v[40:43], v[80:83], 0
    v_mfma_f32_16x16x32_bf16 v[52:55], v[40:43], v[84:87], 0
    s_branch Lm3e_48
Lm3_47:
    v_mov_b32 v48, 0
    v_mov_b32 v49, 0
    v_mov_b32 v50, 0
    v_mov_b32 v51, 0
    v_mov_b32 v52, 0
    v_mov_b32 v53, 0
    v_mov_b32 v54, 0
    v_mov_b32 v55, 0
    s_waitcnt lgkmcnt(0)
Lm3e_48:
    v_mfma_f32_16x16x32_bf16 v[48:51], v[32:35], v[64:67], v[48:51]
    v_mfma_f32_16x16x32_bf16 v[52:55], v[32:35], v[68:71], v[52:55]
    v_mfma_f32_16x16x32_bf16 v[48:51], v[36:39], v[72:75], v[48:51]
    v_mfma_f32_16x16x32_bf16 v[52:55], v[36:39], v[76:79], v[52:55]
    s_mov_b64 s[12:13], exec
    s_mov_b64 exec, 0xffff
    s_nop 6
    ds_write_b32 v29, v48
    ds_write_b32 v29, v49 offset:32
    ds_write_b32 v29, v52 offset:1024
    ds_write_b32 v29, v53 offset:1056
    s_mov_b64 exec, s[12:13]
    s_waitcnt lgkmcnt(0)
    s_barrier
    s_cmp_eq_u32 s4, 7
    s_cbranch_scc0 Lm2e_49
    ds_read_b128 v[16:19], v30
    ds_read_b128 v[20:23], v30 offset:16
    ds_read_b128 v[32:35], v30 offset:32
    ds_read_b128 v[36:39], v30 offset:48
    s_waitcnt lgkmcnt(0)
    v_add_f32 v16, v16, v17
    v_add_f32 v18, v18, v19
    v_add_f32 v20, v20, v21
    v_add_f32 v22, v22, v23
    v_add_f32 v16, v16, v18
    v_add_f32 v20, v20, v22
    v_add_f32 v40, v16, v20
    v_add_f32 v32, v32, v33
    v_add_f32 v34, v34, v35
    v_add_f32 v36, v36, v37
    v_add_f32 v38, v38, v39
    v_add_f32 v32, v32, v34
    v_add_f32 v36, v36, v38
    v_add_f32 v41, v32, v36
    v_mov_b32 v42, 0
    v_mov_b32 v43, s8
    s_mov_b32 exec_hi, 0
    global_store_dwordx4 v31, v[40:43], s[46:47] sc1
    s_mov_b64 exec, -1
Lm2e_49:
Lm2_44:
    v_lshrrev_b32 v16, 2, v2
    v_and_b32 v17, 3, v2
    v_and_b32 v18, 1, v3
    v_lshl_or_b32 v18, v18, 2, v16
    v_xor_b32 v18, s4, v18
    v_lshl_add_u32 v19, v3, 3, v16
    v_lshlrev_b32 v19, 8, v19
    v_lshl_add_u32 v19, v18, 5, v19
    v_lshl_add_u32 v19, v17, 3, v19
    v_add_u32 v7, 81920, v19
    s_lshr_b32 s53, s4, 1
    s_and_b32 s54, s4, 1
    s_lshr_b32 s55, s48, 4
    s_and_b32 s56, s48, 15
    s_lshl_b32 s9, s53, 1
    s_add_u32 s9, s9, s55
    s_lshl_b32 s9, s9, 5
    v_lshl_add_u32 v16, v3, 3, s9
    v_mul_u32_u24 v16, 24576, v16
    s_lshl_b32 s9, s49, 4
    s_add_u32 s9, s9, s56
    s_mul_i32 s9, s9, 24
    s_mul_i32 s10, s54, 12
    s_add_u32 s9, s9, s10
    v_add_u32 v17, s9, v2
    v_lshl_add_u32 v16, v17, 4, v16
    v_add_u32 v100, 1048576, v16
    v_add_u32 v101, 24576, v100
    v_add_u32 v102, 49152, v100
    v_add_u32 v103, 73728, v100
    v_add_u32 v104, 98304, v100
    v_add_u32 v105, 122880, v100
    v_add_u32 v106, 147456, v100
    v_add_u32 v107, 172032, v100
    s_mul_i32 s10, s53, 272
    s_lshl_b32 s11, s54, 7
    s_add_u32 s10, s10, s11
    s_add_u32 s10, s10, 116416
    v_mul_u32_u24 v16, 12, v2
    v_add_u32 v9, s10, v16
    v_add_u32 v10, 4, v9
    v_mov_b32 v17, 117552
    v_cmp_gt_u32 vcc, 11, v2
    s_nop 1
    v_cndmask_b32 v9, v17, v9, vcc
    v_cndmask_b32 v10, v17, v10, vcc
    v_cmp_gt_u32 vcc, 10, v2
    v_add_u32 v11, 8, v9
    s_nop 0
    v_cndmask_b32 v11, v17, v11, vcc
    s_lshl_b32 s9, s53, 2
    s_add_u32 s9, s9, 117504
    v_mov_b32 v12, s9
    v_and_b32 v16, 1, v2
    v_mul_u32_u24 v16, 272, v16
    v_lshl_add_u32 v16, v3, 4, v16
    v_add_u32 v8, 116416, v16
    s_lshl_b32 s9, s49, 5
    s_add_u32 s9, s9, s48
    s_lshl_b32 s9, s9, 7
    s_lshl_b32 s10, s4, 4
    s_add_u32 s9, s9, s10
    v_add_u32 v13, s9, v2
    v_lshlrev_b32 v13, 4, v13
    v_add_u32 v13, 8388608, v13
    s_lshl_b32 s9, s4, 4
    v_add_u32 v16, s9, v2
    v_lshlrev_b32 v16, 3, v16
    v_add_u32 v14, 146080, v16
    v_and_b32 v16, 127, v0
    v_lshlrev_b32 v17, 3, v16
    v_add_u32 v15, 146080, v17
    s_lshl_b32 s9, s49, 5
    s_add_u32 s9, s9, s48
    s_lshl_b32 s9, s9, 7
    v_add_u32 v16, s9, v16
    v_lshlrev_b32 v16, 4, v16
    v_add_u32 v13, 8388608, v16
    s_mov_b32 s57, 0x05040100
    s_mov_b32 s58, 0x07060302
    v_cmp_gt_u32 vcc, 12, v2
    s_mov_b64 s[60:61], vcc
    s_waitcnt vmcnt(0)
    s_barrier
    ds_read_b64_tr_b16 v[128:129], v7 offset:0
    ds_read_b64_tr_b16 v[130:131], v7 offset:1024
    ds_read_b64_tr_b16 v[132:133], v7 offset:8192
    ds_read_b64_tr_b16 v[134:135], v7 offset:9216
    ds_read_b64_tr_b16 v[136:137], v7 offset:16384
    ds_read_b64_tr_b16 v[138:139], v7 offset:17408
    ds_read_b64_tr_b16 v[140:141], v7 offset:24576
    ds_read_b64_tr_b16 v[142:143], v7 offset:25600
    s_cmp_lt_u32 s4, 4
    s_cbranch_scc0 Leb_51
    s_lshl_b32 s9, s53, 1
    s_add_u32 s9, s9, s55
    s_lshl_b32 s9, s9, 5
    v_add_u32 v16, s9, v1
    v_lshlrev_b32 v16, 4, v16
    v_add_u32 v16, 9371648, v16
    s_mov_b32 exec_hi, 0
Les_52:
    global_load_dwordx4 v[20:23], v16, s[46:47] sc1
    s_waitcnt vmcnt(0)
    v_cmp_ne_u32 vcc, s8, v23
    s_cbranch_vccz Lok_53
    s_add_u32 s15, s15, 1
    s_cmp_lt_u32 s15, 200000
    s_cbranch_scc1 Les_52
Lok_53:
    s_mov_b64 exec, s[60:61]
Leg_50:
    global_load_dwordx4 v[64:67], v100, s[46:47] sc1
    global_load_dwordx4 v[68:71], v101, s[46:47] sc1
    global_load_dwordx4 v[72:75], v102, s[46:47] sc1
    global_load_dwordx4 v[76:79], v103, s[46:47] sc1
    global_load_dwordx4 v[80:83], v104, s[46:47] sc1
    global_load_dwordx4 v[84:87], v105, s[46:47] sc1
    global_load_dwordx4 v[88:91], v106, s[46:47] sc1
    global_load_dwordx4 v[92:95], v107, s[46:47] sc1
    s_waitcnt vmcnt(0)
    v_xor_b32 v40, s8, v67
    v_xor_b32 v41, s8, v71
    v_xor_b32 v75, s8, v75
    v_or3_b32 v40, v40, v41, v75
    v_xor_b32 v41, s8, v79
    v_xor_b32 v83, s8, v83
    v_or3_b32 v40, v40, v41, v83
    v_xor_b32 v41, s8, v87
    v_xor_b32 v91, s8, v91
    v_or3_b32 v40, v40, v41, v91
    v_xor_b32 v41, s8, v95
    v_or_b32 v40, v40, v41
    v_cmp_ne_u32 vcc, 0, v40
    s_cbranch_vccz Lok_54
    s_add_u32 s15, s15, 1
    s_cmp_lt_u32 s15, 200000
    s_cbranch_scc1 Leg_50
Lok_54:
    s_mov_b64 exec, -1
    v_max3_f32 v16, v66, v70, v74
    v_max3_f32 v17, v78, v82, v86
    v_max3_f32 v16, v16, v90, v94
    v_max_f32 v16, v16, v17
    v_mov_b32 v17, v16
    s_nop 1
    v_permlane16_swap_b32 v16, v17
    s_nop 1
    v_max_f32 v16, v16, v17
    v_mov_b32 v17, v16
    s_nop 1
    v_permlane32_swap_b32 v16, v17
    s_nop 1
    v_max_f32 v16, v16, v17
    v_sub_f32 v20, v66, v16
    v_sub_f32 v21, v70, v16
    v_sub_f32 v22, v74, v16
    v_sub_f32 v23, v78, v16
    v_sub_f32 v24, v82, v16
    v_sub_f32 v25, v86, v16
    v_sub_f32 v26, v90, v16
    v_sub_f32 v27, v94, v16
    v_exp_f32 v20, v20
    v_exp_f32 v21, v21
    v_exp_f32 v22, v22
    v_exp_f32 v23, v23
    v_exp_f32 v24, v24
    v_exp_f32 v25, v25
    v_exp_f32 v26, v26
    v_exp_f32 v27, v27
    v_perm_b32 v144, v68, v64, s57
    v_perm_b32 v148, v68, v64, s58
    v_perm_b32 v145, v76, v72, s57
    v_perm_b32 v149, v76, v72, s58
    v_perm_b32 v146, v84, v80, s57
    v_perm_b32 v150, v84, v80, s58
    v_perm_b32 v147, v92, v88, s57
    v_perm_b32 v151, v92, v88, s58
    v_cvt_pk_bf16_f32 v28, v20, v21
    v_cvt_pk_bf16_f32 v29, v22, v23
    v_cvt_pk_bf16_f32 v30, v24, v25
    v_cvt_pk_bf16_f32 v31, v26, v27
    v_perm_b32 v152, v69, v65, s57
    v_perm_b32 v156, v69, v65, s58
    v_perm_b32 v153, v77, v73, s57
    v_perm_b32 v157, v77, v73, s58
    v_perm_b32 v154, v85, v81, s57
    v_perm_b32 v158, v85, v81, s58
    v_perm_b32 v155, v93, v89, s57
    v_perm_b32 v159, v93, v89, s58
    v_perm_b32 v160, v70, v66, s57
    v_perm_b32 v164, v70, v66, s58
    v_perm_b32 v161, v78, v74, s57
    v_perm_b32 v165, v78, v74, s58
    v_perm_b32 v162, v86, v82, s57
    v_perm_b32 v166, v86, v82, s58
    v_perm_b32 v163, v94, v90, s57
    v_perm_b32 v167, v94, v90, s58
    s_nop 1
    v_mfma_f32_16x16x32_bf16 v[168:171], v[28:31], v[144:147], 0
    v_mfma_f32_16x16x32_bf16 v[172:175], v[28:31], v[148:151], 0
    v_mfma_f32_16x16x32_bf16 v[176:179], v[28:31], v[152:155], 0
    v_mfma_f32_16x16x32_bf16 v[180:183], v[28:31], v[156:159], 0
    v_mfma_f32_16x16x32_bf16 v[184:187], v[28:31], v[160:163], 0
    v_mfma_f32_16x16x32_bf16 v[188:191], v[28:31], v[164:167], 0
    s_mov_b32 exec_lo, 0
    s_mov_b32 exec_hi, 0xffff
    s_nop 6
    v_cvt_pk_bf16_f32 v32, v170, v174
    v_cvt_pk_bf16_f32 v33, v178, v182
    v_cvt_pk_bf16_f32 v34, v186, v190
    v_add_f32 v17, v170, v174
    ds_write_b32 v9, v32
    ds_write_b32 v10, v33
    ds_write_b32 v11, v34
    s_mov_b32 exec_hi, 0x800
    ds_write_b32 v12, v17
    s_mov_b64 exec, -1
Leb_51:
    s_waitcnt lgkmcnt(0)
    s_barrier
    ds_read_b128 v[16:19], v8 offset:0
    ds_read_b128 v[20:23], v8 offset:64
    ds_read_b128 v[24:27], v8 offset:128
    ds_read_b128 v[28:31], v8 offset:192
    v_mov_b32 v32, 117504
    ds_read_b64 v[36:37], v32
    v_mov_b32 v54, 0
    v_mov_b32 v55, s8
    s_waitcnt lgkmcnt(4)
    v_mfma_f32_16x16x32_bf16 v[44:47], v[16:19], v[128:131], 0
    s_waitcnt lgkmcnt(3)
    v_mfma_f32_16x16x32_bf16 v[44:47], v[20:23], v[132:135], v[44:47]
    s_waitcnt lgkmcnt(2)
    v_mfma_f32_16x16x32_bf16 v[44:47], v[24:27], v[136:139], v[44:47]
    s_waitcnt lgkmcnt(1)
    v_mfma_f32_16x16x32_bf16 v[44:47], v[28:31], v[140:143], v[44:47]
    s_waitcnt lgkmcnt(0)
    v_rcp_f32 v36, v36
    v_rcp_f32 v37, v37
    s_mov_b64 exec, 0xffff
    s_nop 4
    v_mul_f32 v52, v36, v44
    v_mul_f32 v53, v37, v45
    ds_write_b64 v14, v[52:53]
    s_mov_b64 exec, -1
    s_waitcnt lgkmcnt(0)
    s_barrier
    s_and_b32 s9, s4, 6
    s_cmp_eq_u32 s9, 4
    s_cbranch_scc0 Lep_55
    ds_read_b64 v[52:53], v15
    s_waitcnt lgkmcnt(0)
    global_store_dwordx4 v13, v[52:55], s[46:47] sc1
Lep_55:
    s_barrier
    s_cmp_eq_u32 s5, 15
    s_cbranch_scc0 Lm2_56
    s_add_u32 s52, s6, 72
    s_lshl_b32 s13, s52, 6
    s_add_u32 s13, s13, 2560
    s_barrier
    v_lshrrev_b32 v44, 2, v1
    v_and_b32 v45, 3, v1
    v_lshrrev_b32 v46, 1, v45
    v_lshrrev_b32 v47, 5, v1
    v_xor_b32 v46, v46, v47
    v_and_b32 v45, 1, v45
    v_lshl_or_b32 v46, v46, 1, v45
    s_lshl_b32 s9, s4, 4
    v_add_u32 v44, s9, v44
    v_mul_u32_u24 v44, 7680, v44
    v_lshl_add_u32 v44, v46, 4, v44
    v_add_u32 v44, s13, v44
    s_lshl_b32 s11, s4, 10
    s_add_u32 s11, s11, 0
    s_mov_b32 m0, s11
    s_add_u32 s11, s11, 8192
    global_load_lds_dwordx4 v44, s[40:41] nt
    v_add_u32 v44, 983040, v44
    s_mov_b32 m0, s11
    s_add_u32 s11, s11, 8192
    global_load_lds_dwordx4 v44, s[40:41] nt
    v_add_u32 v44, 983040, v44
    s_mov_b32 m0, s11
    s_add_u32 s11, s11, 8192
    global_load_lds_dwordx4 v44, s[40:41] nt
    v_add_u32 v44, 983040, v44
    s_mov_b32 m0, s11
    s_add_u32 s11, s11, 8192
    global_load_lds_dwordx4 v44, s[40:41] nt
    v_add_u32 v44, 983040, v44
    s_mov_b32 m0, s11
    s_add_u32 s11, s11, 8192
    global_load_lds_dwordx4 v44, s[40:41] nt
    v_cmp_gt_u32 vcc, 320, v0
    s_and_saveexec_b64 s[12:13], vcc
    s_cbranch_execz Lm2s_57
    v_lshlrev_b32 v16, 2, v0
    global_load_dword v18, v16, s[38:39]
    global_load_dword v19, v16, s[38:39] offset:1280
    s_waitcnt vmcnt(0)
    v_lshlrev_b32 v20, 16, v18
    v_and_b32 v21, 0xffff0000, v18
    v_mul_f32 v22, 0xbfb8aa3b, v20
    v_mul_f32 v23, 0xbfb8aa3b, v21
    v_exp_f32 v22, v22
    v_exp_f32 v23, v23
    s_nop 0
    v_add_f32 v22, 1.0, v22
    v_add_f32 v23, 1.0, v23
    v_rcp_f32 v22, v22
    v_rcp_f32 v23, v23
    s_nop 0
    v_mul_f32 v20, v20, v22
    v_mul_f32 v21, v21, v23
    v_cvt_pk_bf16_f32 v24, v20, v21
    v_lshlrev_b32 v20, 16, v19
    v_and_b32 v21, 0xffff0000, v19
    v_mul_f32 v22, 0xbfb8aa3b, v20
    v_mul_f32 v23, 0xbfb8aa3b, v21
    v_exp_f32 v22, v22
    v_exp_f32 v23, v23
    s_nop 0
    v_add_f32 v22, 1.0, v22
    v_add_f32 v23, 1.0, v23
    v_rcp_f32 v22, v22
    v_rcp_f32 v23, v23
    s_nop 0
    v_mul_f32 v20, v20, v22
    v_mul_f32 v21, v21, v23
    v_cvt_pk_bf16_f32 v25, v20, v21
    v_add_u32 v16, 147104, v16
    ds_write_b32 v16, v24
    ds_write_b32 v16, v25 offset:1296
Lm2s_57:
    s_mov_b64 exec, s[12:13]
    v_lshrrev_b32 v16, 2, v2
    v_and_b32 v17, 3, v2
    v_lshl_add_u32 v18, v3, 3, v16
    v_lshlrev_b32 v18, 6, v18
    v_lshl_add_u32 v18, v17, 3, v18
    s_lshl_b32 s9, s4, 11
    s_add_u32 s9, s9, 0
    v_add_u32 v18, s9, v18
    v_and_b32 v19, 1, v3
    v_lshl_add_u32 v26, v19, 5, v18
    v_xor_b32 v19, 1, v19
    v_lshl_add_u32 v27, v19, 5, v18
    v_and_b32 v16, 1, v2
    v_mul_u32_u24 v16, 1296, v16
    v_lshl_add_u32 v16, v3, 4, v16
    s_lshl_b32 s9, s4, 6
    s_add_u32 s9, s9, 147104
    v_add_u32 v28, s9, v16
    v_lshlrev_b32 v16, 6, v2
    s_lshl_b32 s9, s4, 2
    s_add_u32 s9, s9, 140768
    v_add_u32 v29, s9, v16
    v_lshlrev_b32 v16, 6, v1
    v_add_u32 v30, 140768, v16
    s_lshl_b32 s9, s52, 5
    v_add_u32 v16, s9, v1
    v_lshlrev_b32 v16, 4, v16
    v_add_u32 v31, 4096, v16
    s_waitcnt vmcnt(0) lgkmcnt(0)
    s_barrier
    ds_read_b64_tr_b16 v[64:65], v26 offset:0
    ds_read_b64_tr_b16 v[66:67], v26 offset:256
    ds_read_b64_tr_b16 v[68:69], v27 offset:0
    ds_read_b64_tr_b16 v[70:71], v27 offset:256
    ds_read_b64_tr_b16 v[72:73], v26 offset:16384
    ds_read_b64_tr_b16 v[74:75], v26 offset:16640
    ds_read_b64_tr_b16 v[76:77], v27 offset:16384
    ds_read_b64_tr_b16 v[78:79], v27 offset:16640
    s_cmp_lt_u32 s4, 4
    s_cbranch_scc0 Lt3_58
    ds_read_b64_tr_b16 v[80:81], v26 offset:32768
    ds_read_b64_tr_b16 v[82:83], v26 offset:33024
    ds_read_b64_tr_b16 v[84:85], v27 offset:32768
    ds_read_b64_tr_b16 v[86:87], v27 offset:33024
Lt3_58:
    ds_read_b128 v[32:35], v28
    ds_read_b128 v[36:39], v28 offset:512
    s_cmp_lt_u32 s4, 4
    s_cbranch_scc0 Lm3_59
    ds_read_b128 v[40:43], v28 offset:1024
    s_waitcnt lgkmcnt(0)
    v_mfma_f32_16x16x32_bf16 v[48:51], v[40:43], v[80:83], 0
    v_mfma_f32_16x16x32_bf16 v[52:55], v[40:43], v[84:87], 0
    s_branch Lm3e_60
Lm3_59:
    v_mov_b32 v48, 0
    v_mov_b32 v49, 0
    v_mov_b32 v50, 0
    v_mov_b32 v51, 0
    v_mov_b32 v52, 0
    v_mov_b32 v53, 0
    v_mov_b32 v54, 0
    v_mov_b32 v55, 0
    s_waitcnt lgkmcnt(0)
Lm3e_60:
    v_mfma_f32_16x16x32_bf16 v[48:51], v[32:35], v[64:67], v[48:51]
    v_mfma_f32_16x16x32_bf16 v[52:55], v[32:35], v[68:71], v[52:55]
    v_mfma_f32_16x16x32_bf16 v[48:51], v[36:39], v[72:75], v[48:51]
    v_mfma_f32_16x16x32_bf16 v[52:55], v[36:39], v[76:79], v[52:55]
    s_mov_b64 s[12:13], exec
    s_mov_b64 exec, 0xffff
    s_nop 6
    ds_write_b32 v29, v48
    ds_write_b32 v29, v49 offset:32
    ds_write_b32 v29, v52 offset:1024
    ds_write_b32 v29, v53 offset:1056
    s_mov_b64 exec, s[12:13]
    s_waitcnt lgkmcnt(0)
    s_barrier
    s_cmp_eq_u32 s4, 7
    s_cbranch_scc0 Lm2e_61
    ds_read_b128 v[16:19], v30
    ds_read_b128 v[20:23], v30 offset:16
    ds_read_b128 v[32:35], v30 offset:32
    ds_read_b128 v[36:39], v30 offset:48
    s_waitcnt lgkmcnt(0)
    v_add_f32 v16, v16, v17
    v_add_f32 v18, v18, v19
    v_add_f32 v20, v20, v21
    v_add_f32 v22, v22, v23
    v_add_f32 v16, v16, v18
    v_add_f32 v20, v20, v22
    v_add_f32 v40, v16, v20
    v_add_f32 v32, v32, v33
    v_add_f32 v34, v34, v35
    v_add_f32 v36, v36, v37
    v_add_f32 v38, v38, v39
    v_add_f32 v32, v32, v34
    v_add_f32 v36, v36, v38
    v_add_f32 v41, v32, v36
    v_mov_b32 v42, 0
    v_mov_b32 v43, s8
    s_mov_b32 exec_hi, 0
    global_store_dwordx4 v31, v[40:43], s[46:47] sc1
    s_mov_b64 exec, -1
Lm2e_61:
Lm2_56:
    s_cmp_lt_u32 s5, 7
    s_cbranch_scc0 Lgend_62
    s_cmp_lt_u32 s52, 54
    s_cbranch_scc0 Lgend_62
    v_lshlrev_b32 v5, 4, v0
    v_add_u32 v5, 4096, v5
    v_add_u32 v6, 10240, v5
    v_add_u32 v7, 20480, v5
    v_add_u32 v8, 8192, v5
    v_add_u32 v9, 18432, v5
    v_add_u32 v10, 28672, v5
    v_mov_b32 v31, s8
    v_mov_b32 v35, s8
    v_mov_b32 v39, s8
    v_lshrrev_b32 v16, 2, v2
    v_and_b32 v17, 3, v2
    v_lshl_add_u32 v18, v3, 3, v16
    v_lshlrev_b32 v18, 6, v18
    v_lshl_add_u32 v18, v17, 3, v18
    s_lshl_b32 s9, s4, 11
    s_add_u32 s9, s9, 0
    v_add_u32 v18, s9, v18
    v_and_b32 v19, 1, v3
    v_lshl_add_u32 v26, v19, 5, v18
    v_xor_b32 v19, 1, v19
    v_lshl_add_u32 v27, v19, 5, v18
    ds_read_b64_tr_b16 v[64:65], v26 offset:0
    ds_read_b64_tr_b16 v[66:67], v26 offset:256
    ds_read_b64_tr_b16 v[68:69], v27 offset:0
    ds_read_b64_tr_b16 v[70:71], v27 offset:256
    ds_read_b64_tr_b16 v[72:73], v26 offset:16384
    ds_read_b64_tr_b16 v[74:75], v26 offset:16640
    ds_read_b64_tr_b16 v[76:77], v27 offset:16384
    ds_read_b64_tr_b16 v[78:79], v27 offset:16640
    s_cmp_lt_u32 s4, 4
    s_cbranch_scc0 Lt3_63
    ds_read_b64_tr_b16 v[80:81], v26 offset:32768
    ds_read_b64_tr_b16 v[82:83], v26 offset:33024
    ds_read_b64_tr_b16 v[84:85], v27 offset:32768
    ds_read_b64_tr_b16 v[86:87], v27 offset:33024
Lt3_63:
    v_lshlrev_b32 v192, 16, v193
    v_and_b32 v193, 0xffff0000, v193
    v_lshlrev_b32 v200, 16, v201
    v_and_b32 v201, 0xffff0000, v201
    v_lshlrev_b32 v208, 16, v209
    v_and_b32 v209, 0xffff0000, v209
    v_lshlrev_b32 v216, 16, v217
    v_and_b32 v217, 0xffff0000, v217
    v_lshlrev_b32 v234, 16, v234
Lgm_64:
    global_load_dwordx4 v[16:19], v5, s[46:47] sc1
    global_load_dwordx4 v[20:23], v6, s[46:47] sc1
    global_load_dwordx4 v[24:27], v7, s[46:47] sc1
    s_cmp_lt_u32 s4, 2
    s_cbranch_scc0 Lgm2_65
    global_load_dwordx4 v[28:31], v8, s[46:47] sc1
    global_load_dwordx4 v[32:35], v9, s[46:47] sc1
    global_load_dwordx4 v[36:39], v10, s[46:47] sc1
Lgm2_65:
    s_waitcnt vmcnt(0)
    v_xor_b32 v40, s8, v19
    v_xor_b32 v41, s8, v23
    v_xor_b32 v27, s8, v27
    v_or3_b32 v40, v40, v41, v27
    v_xor_b32 v41, s8, v31
    v_xor_b32 v35, s8, v35
    v_or3_b32 v40, v40, v41, v35
    v_xor_b32 v41, s8, v39
    v_or_b32 v40, v40, v41
    v_cmp_ne_u32 vcc, 0, v40
    s_cbranch_vccz Lok_66
    s_add_u32 s15, s15, 1
    s_cmp_lt_u32 s15, 200000
    s_cbranch_scc1 Lgm_64
Lok_66:
    s_lshl_b32 s9, s4, 6
    v_add_u32 v44, s9, v1
    s_mov_b32 s10, 52429
    s_mul_i32 s13, s52, 40960
    s_lshl_b32 s11, s4, 10
    s_add_u32 s11, s11, 40960
    v_mul_u32_u24 v45, s10, v44
    v_lshrrev_b32 v45, 22, v45
    v_mul_u32_u24 v46, 80, v45
    v_sub_u32 v46, v44, v46
    v_and_b32 v47, 3, v45
    v_bfe_u32 v48, v45, 3, 1
    v_lshl_or_b32 v47, v48, 2, v47
    v_lshlrev_b32 v47, 1, v47
    v_xor_b32 v46, v46, v47
    v_mul_u32_u24 v45, 1280, v45
    v_lshl_add_u32 v45, v46, 4, v45
    v_add_u32 v45, s13, v45
    s_mov_b32 m0, s11
    s_add_u32 s11, s11, 8192
    global_load_lds_dwordx4 v45, s[34:35] nt
    v_add_u32 v44, 512, v44
    v_mul_u32_u24 v45, s10, v44
    v_lshrrev_b32 v45, 22, v45
    v_mul_u32_u24 v46, 80, v45
    v_sub_u32 v46, v44, v46
    v_and_b32 v47, 3, v45
    v_bfe_u32 v48, v45, 3, 1
    v_lshl_or_b32 v47, v48, 2, v47
    v_lshlrev_b32 v47, 1, v47
    v_xor_b32 v46, v46, v47
    v_mul_u32_u24 v45, 1280, v45
    v_lshl_add_u32 v45, v46, 4, v45
    v_add_u32 v45, s13, v45
    s_mov_b32 m0, s11
    s_add_u32 s11, s11, 8192
    global_load_lds_dwordx4 v45, s[34:35] nt
    v_add_u32 v44, 512, v44
    v_mul_u32_u24 v45, s10, v44
    v_lshrrev_b32 v45, 22, v45
    v_mul_u32_u24 v46, 80, v45
    v_sub_u32 v46, v44, v46
    v_and_b32 v47, 3, v45
    v_bfe_u32 v48, v45, 3, 1
    v_lshl_or_b32 v47, v48, 2, v47
    v_lshlrev_b32 v47, 1, v47
    v_xor_b32 v46, v46, v47
    v_mul_u32_u24 v45, 1280, v45
    v_lshl_add_u32 v45, v46, 4, v45
    v_add_u32 v45, s13, v45
    s_mov_b32 m0, s11
    s_add_u32 s11, s11, 8192
    global_load_lds_dwordx4 v45, s[34:35] nt
    v_add_u32 v44, 512, v44
    v_mul_u32_u24 v45, s10, v44
    v_lshrrev_b32 v45, 22, v45
    v_mul_u32_u24 v46, 80, v45
    v_sub_u32 v46, v44, v46
    v_and_b32 v47, 3, v45
    v_bfe_u32 v48, v45, 3, 1
    v_lshl_or_b32 v47, v48, 2, v47
    v_lshlrev_b32 v47, 1, v47
    v_xor_b32 v46, v46, v47
    v_mul_u32_u24 v45, 1280, v45
    v_lshl_add_u32 v45, v46, 4, v45
    v_add_u32 v45, s13, v45
    s_mov_b32 m0, s11
    s_add_u32 s11, s11, 8192
    global_load_lds_dwordx4 v45, s[34:35] nt
    v_add_u32 v44, 512, v44
    v_mul_u32_u24 v45, s10, v44
    v_lshrrev_b32 v45, 22, v45
    v_mul_u32_u24 v46, 80, v45
    v_sub_u32 v46, v44, v46
    v_and_b32 v47, 3, v45
    v_bfe_u32 v48, v45, 3, 1
    v_lshl_or_b32 v47, v48, 2, v47
    v_lshlrev_b32 v47, 1, v47
    v_xor_b32 v46, v46, v47
    v_mul_u32_u24 v45, 1280, v45
    v_lshl_add_u32 v45, v46, 4, v45
    v_add_u32 v45, s13, v45
    s_mov_b32 m0, s11
    s_add_u32 s11, s11, 8192
    global_load_lds_dwordx4 v45, s[34:35] nt
    v_add_u32 v44, 512, v44
    v_lshlrev_b32 v42, 2, v0
    v_add_u32 v42, 117568, v42
    ds_write_b32 v42, v16
    ds_write_b32 v42, v17 offset:2560
    v_add_f32 v24, 1.0, v24
    v_add_f32 v25, 1.0, v25
    ds_write_b32 v42, v24 offset:5120
    ds_write_b32 v42, v25 offset:7680
    v_cvt_pk_bf16_f32 v43, v24, v25
    v_cvt_pk_bf16_f32 v44, v20, v21
    v_lshlrev_b32 v42, 1, v0
    v_add_u32 v42, 127808, v42
    ds_write_b16 v42, v43
    ds_write_b16_d16_hi v42, v43 offset:1296
    ds_write_b16 v42, v44 offset:2592
    ds_write_b16_d16_hi v42, v44 offset:3888
    s_cmp_lt_u32 s4, 2
    s_cbranch_scc0 Lgm3_67
    v_lshlrev_b32 v42, 2, v0
    v_add_u32 v42, 119616, v42
    ds_write_b32 v42, v28
    ds_write_b32 v42, v29 offset:2560
    v_add_f32 v36, 1.0, v36
    v_add_f32 v37, 1.0, v37
    ds_write_b32 v42, v36 offset:5120
    ds_write_b32 v42, v37 offset:7680
    v_cvt_pk_bf16_f32 v43, v36, v37
    v_cvt_pk_bf16_f32 v44, v32, v33
    v_lshlrev_b32 v42, 1, v0
    v_add_u32 v42, 128832, v42
    ds_write_b16 v42, v43
    ds_write_b16_d16_hi v42, v43 offset:1296
    ds_write_b16 v42, v44 offset:2592
    ds_write_b16_d16_hi v42, v44 offset:3888
Lgm3_67:
    s_waitcnt lgkmcnt(0)
    s_barrier
    v_lshrrev_b32 v16, 2, v2
    v_and_b32 v17, 3, v2
    v_and_b32 v18, 1, v3
    v_lshl_or_b32 v18, v18, 2, v16
    v_lshl_add_u32 v19, v3, 3, v16
    v_mul_u32_u24 v19, 1280, v19
    v_lshl_add_u32 v19, v17, 3, v19
    v_add_u32 v19, 40960, v19
    s_mul_i32 s9, s4, 5
    s_add_u32 s10, s9, 0
    v_xor_b32 v20, s10, v18
    v_lshl_add_u32 v170, v20, 5, v19
    s_add_u32 s10, s9, 1
    v_xor_b32 v20, s10, v18
    v_lshl_add_u32 v171, v20, 5, v19
    s_add_u32 s10, s9, 2
    v_xor_b32 v20, s10, v18
    v_lshl_add_u32 v172, v20, 5, v19
    s_add_u32 s10, s9, 3
    v_xor_b32 v20, s10, v18
    v_lshl_add_u32 v173, v20, 5, v19
    s_add_u32 s10, s9, 4
    v_xor_b32 v20, s10, v18
    v_lshl_add_u32 v174, v20, 5, v19
    ds_read_b64 v[194:195], v230
    ds_read_b64 v[196:197], v230 offset:5120
    ds_read_b64 v[202:203], v231
    ds_read_b64 v[204:205], v231 offset:5120
    ds_read_b64 v[210:211], v232
    ds_read_b64 v[212:213], v232 offset:5120
    ds_read_b64 v[218:219], v233
    ds_read_b64 v[220:221], v233 offset:5120
    ds_read_b128 v[32:35], v226
    ds_read_b128 v[36:39], v226 offset:512
    s_cmp_lt_u32 s4, 4
    s_cbranch_scc0 Lm3_68
    ds_read_b128 v[40:43], v226 offset:1024
    s_waitcnt lgkmcnt(0)
    v_mfma_f32_16x16x32_bf16 v[48:51], v[40:43], v[80:83], 0
    v_mfma_f32_16x16x32_bf16 v[52:55], v[40:43], v[84:87], 0
    s_branch Lm3e_69
Lm3_68:
    v_mov_b32 v48, 0
    v_mov_b32 v49, 0
    v_mov_b32 v50, 0
    v_mov_b32 v51, 0
    v_mov_b32 v52, 0
    v_mov_b32 v53, 0
    v_mov_b32 v54, 0
    v_mov_b32 v55, 0
    s_waitcnt lgkmcnt(0)
Lm3e_69:
    v_mfma_f32_16x16x32_bf16 v[48:51], v[32:35], v[64:67], v[48:51]
    v_mfma_f32_16x16x32_bf16 v[52:55], v[32:35], v[68:71], v[52:55]
    v_mfma_f32_16x16x32_bf16 v[48:51], v[36:39], v[72:75], v[48:51]
    v_mfma_f32_16x16x32_bf16 v[52:55], v[36:39], v[76:79], v[52:55]
    s_mov_b64 exec, 0xffff
    s_nop 6
    ds_write_b32 v228, v48 offset:0
    ds_write_b32 v228, v52 offset:2048
    ds_write_b32 v228, v49 offset:32
    ds_write_b32 v228, v53 offset:2080
    ds_write_b32 v228, v50 offset:64
    ds_write_b32 v228, v54 offset:2112
    ds_write_b32 v228, v51 offset:96
    ds_write_b32 v228, v55 offset:2144
    s_mov_b64 exec, -1
    s_waitcnt lgkmcnt(0)
    s_barrier
    ds_read_b128 v[32:35], v229
    ds_read_b128 v[36:39], v229 offset:16
    ds_read_b128 v[40:43], v229 offset:64
    ds_read_b128 v[44:47], v229 offset:80
    s_waitcnt lgkmcnt(0)
    v_add_f32 v32, v32, v33
    v_add_f32 v34, v34, v35
    v_add_f32 v36, v36, v37
    v_add_f32 v38, v38, v39
    v_add_f32 v32, v32, v34
    v_add_f32 v36, v36, v38
    v_add_f32 v224, v32, v36
    v_add_f32 v40, v40, v41
    v_add_f32 v42, v42, v43
    v_add_f32 v44, v44, v45
    v_add_f32 v46, v46, v47
    v_add_f32 v40, v40, v42
    v_add_f32 v44, v44, v46
    v_add_f32 v225, v40, v44
    v_add_f32 v225, v225, v234
    s_barrier
    v_mov_b32 v27, s8
    v_mov_b32 v31, s8
Lgg_70:
    global_load_dwordx4 v[16:19], v249, s[46:47] sc1
    global_load_dwordx4 v[20:23], v250, s[46:47] sc1
    s_cmp_lt_u32 s4, 6
    s_cbranch_scc0 Lgg1_71
    global_load_dwordx4 v[24:27], v251, s[46:47] sc1
    global_load_dwordx4 v[28:31], v252, s[46:47] sc1
Lgg1_71:
    s_waitcnt vmcnt(0)
    v_xor_b32 v40, s8, v19
    v_xor_b32 v41, s8, v23
    v_xor_b32 v27, s8, v27
    v_or3_b32 v40, v40, v41, v27
    v_xor_b32 v41, s8, v31
    v_or_b32 v40, v40, v41
    v_cmp_ne_u32 vcc, 0, v40
    s_cbranch_vccz Lok_72
    s_add_u32 s15, s15, 1
    s_cmp_lt_u32 s15, 200000
    s_cbranch_scc1 Lgg_70
Lok_72:
    s_nop 1
    v_mfma_f32_16x16x32_bf16 v[32:35], v[236:239], v[16:19], 0
    v_mfma_f32_16x16x32_bf16 v[36:39], v[236:239], v[24:27], 0
    v_mfma_f32_16x16x32_bf16 v[32:35], v[236:239], v[20:23], v[32:35]
    v_mfma_f32_16x16x32_bf16 v[36:39], v[236:239], v[28:31], v[36:39]
    s_nop 7
    v_fma_f32 v44, v194, v32, v192
    v_fma_f32 v45, v195, v33, v193
    v_mul_f32 v46, v44, v196
    v_mul_f32 v47, v45, v197
    v_mul_f32 v48, v44, v44
    v_mul_f32 v49, v45, v45
    v_cvt_pk_bf16_f32 v46, v46, v47
    v_cvt_pk_bf16_f32 v47, v44, v45
    v_cvt_pk_bf16_f32 v48, v48, v49
    ds_write_b32 v198, v46
    ds_write_b32 v198, v47 offset:2592
    ds_write_b32 v198, v48 offset:5184
    v_fma_f32 v52, v202, v34, v200
    v_fma_f32 v53, v203, v35, v201
    v_mul_f32 v54, v52, v204
    v_mul_f32 v55, v53, v205
    v_mul_f32 v56, v52, v52
    v_mul_f32 v57, v53, v53
    v_cvt_pk_bf16_f32 v54, v54, v55
    v_cvt_pk_bf16_f32 v55, v52, v53
    v_cvt_pk_bf16_f32 v56, v56, v57
    ds_write_b32 v206, v54
    ds_write_b32 v206, v55 offset:2592
    ds_write_b32 v206, v56 offset:5184
    s_add_u32 s9, s4, 0
    s_cmp_eq_u32 s9, s52
    s_cbranch_scc0 Lgp_74
    v_mov_b32 v160, v44
    v_mov_b32 v161, s8
    v_mov_b32 v162, v45
    v_mov_b32 v163, s8
    global_store_dwordx4 v199, v[160:163], s[46:47] sc1
    v_mov_b32 v164, v52
    v_mov_b32 v165, s8
    v_mov_b32 v166, v53
    v_mov_b32 v167, s8
    global_store_dwordx4 v207, v[164:167], s[46:47] sc1
Lgp_74:
    s_cmp_lt_u32 s4, 6
    s_cbranch_scc0 Lgs_75
    v_fma_f32 v44, v210, v36, v208
    v_fma_f32 v45, v211, v37, v209
    v_mul_f32 v46, v44, v212
    v_mul_f32 v47, v45, v213
    v_mul_f32 v48, v44, v44
    v_mul_f32 v49, v45, v45
    v_cvt_pk_bf16_f32 v46, v46, v47
    v_cvt_pk_bf16_f32 v47, v44, v45
    v_cvt_pk_bf16_f32 v48, v48, v49
    ds_write_b32 v214, v46
    ds_write_b32 v214, v47 offset:2592
    ds_write_b32 v214, v48 offset:5184
    v_fma_f32 v52, v218, v38, v216
    v_fma_f32 v53, v219, v39, v217
    v_mul_f32 v54, v52, v220
    v_mul_f32 v55, v53, v221
    v_mul_f32 v56, v52, v52
    v_mul_f32 v57, v53, v53
    v_cvt_pk_bf16_f32 v54, v54, v55
    v_cvt_pk_bf16_f32 v55, v52, v53
    v_cvt_pk_bf16_f32 v56, v56, v57
    ds_write_b32 v222, v54
    ds_write_b32 v222, v55 offset:2592
    ds_write_b32 v222, v56 offset:5184
    s_add_u32 s9, s4, 8
    s_cmp_eq_u32 s9, s52
    s_cbranch_scc0 Lgp_76
    v_mov_b32 v160, v44
    v_mov_b32 v161, s8
    v_mov_b32 v162, v45
    v_mov_b32 v163, s8
    global_store_dwordx4 v215, v[160:163], s[46:47] sc1
    v_mov_b32 v164, v52
    v_mov_b32 v165, s8
    v_mov_b32 v166, v53
    v_mov_b32 v167, s8
    global_store_dwordx4 v223, v[164:167], s[46:47] sc1
Lgp_76:
Lgs_75:
    s_waitcnt lgkmcnt(0)
    s_barrier
    ds_read_b64_tr_b16 v[96:97], v170
    ds_read_b64_tr_b16 v[98:99], v170 offset:5120
    ds_read_b64_tr_b16 v[100:101], v171
    ds_read_b64_tr_b16 v[102:103], v171 offset:5120
    ds_read_b64_tr_b16 v[104:105], v172
    ds_read_b64_tr_b16 v[106:107], v172 offset:5120
    ds_read_b64_tr_b16 v[108:109], v173
    ds_read_b64_tr_b16 v[110:111], v173 offset:5120
    ds_read_b64_tr_b16 v[112:113], v174
    ds_read_b64_tr_b16 v[114:115], v174 offset:5120
    ds_read_b128 v[32:35], v227
    ds_read_b128 v[36:39], v227 offset:512
    s_cmp_lt_u32 s4, 4
    s_cbranch_scc0 Lm3_77
    ds_read_b128 v[40:43], v227 offset:1024
    s_waitcnt lgkmcnt(0)
    v_mfma_f32_16x16x32_bf16 v[48:51], v[40:43], v[80:83], 0
    v_mfma_f32_16x16x32_bf16 v[52:55], v[40:43], v[84:87], 0
    v_mfma_f32_16x16x32_bf16 v[56:59], v[40:43], v[240:243], 0
    s_branch Lm3e_78
Lm3_77:
    v_mov_b32 v48, 0
    v_mov_b32 v49, 0
    v_mov_b32 v50, 0
    v_mov_b32 v51, 0
    v_mov_b32 v52, 0
    v_mov_b32 v53, 0
    v_mov_b32 v54, 0
    v_mov_b32 v55, 0
    v_mov_b32 v56, 0
    v_mov_b32 v57, 0
    v_mov_b32 v58, 0
    v_mov_b32 v59, 0
    s_waitcnt lgkmcnt(0)
Lm3e_78:
    v_mfma_f32_16x16x32_bf16 v[48:51], v[32:35], v[64:67], v[48:51]
    v_mfma_f32_16x16x32_bf16 v[52:55], v[32:35], v[68:71], v[52:55]
    v_mfma_f32_16x16x32_bf16 v[56:59], v[32:35], v[240:243], v[56:59]
    v_mfma_f32_16x16x32_bf16 v[48:51], v[36:39], v[72:75], v[48:51]
    v_mfma_f32_16x16x32_bf16 v[52:55], v[36:39], v[76:79], v[52:55]
    v_mfma_f32_16x16x32_bf16 v[56:59], v[36:39], v[240:243], v[56:59]
    s_mov_b64 exec, 0xffff
    s_nop 6
    ds_write_b32 v228, v48
    ds_write_b32 v228, v49 offset:32
    ds_write_b32 v228, v52 offset:2048
    ds_write_b32 v228, v53 offset:2080
    s_mov_b64 exec, 1
    ds_write_b32 v247, v58
    ds_write_b32 v247, v59 offset:32
    s_mov_b64 exec, 0x10000
    ds_write_b32 v247, v56 offset:64
    ds_write_b32 v247, v57 offset:96
    s_mov_b64 exec, -1
    s_waitcnt lgkmcnt(0)
    s_barrier
    ds_read_b128 v[32:35], v229
    ds_read_b128 v[36:39], v229 offset:16
    ds_read_b128 v[40:43], v248
    ds_read_b128 v[44:47], v248 offset:16
    ds_read_b128 v[48:51], v248 offset:64
    ds_read_b128 v[52:55], v248 offset:80
    s_waitcnt lgkmcnt(2)
    v_add_f32 v40, v40, v41
    v_add_f32 v42, v42, v43
    v_add_f32 v44, v44, v45
    v_add_f32 v46, v46, v47
    v_add_f32 v40, v40, v42
    v_add_f32 v44, v44, v46
    v_add_f32 v40, v40, v44
    v_add_f32 v32, v32, v33
    v_add_f32 v34, v34, v35
    v_add_f32 v36, v36, v37
    v_add_f32 v38, v38, v39
    v_add_f32 v32, v32, v34
    v_add_f32 v36, v36, v38
    v_add_f32 v32, v32, v36
    s_waitcnt lgkmcnt(0)
    v_add_f32 v48, v48, v49
    v_add_f32 v50, v50, v51
    v_add_f32 v52, v52, v53
    v_add_f32 v54, v54, v55
    v_add_f32 v48, v48, v50
    v_add_f32 v52, v52, v54
    v_add_f32 v48, v48, v52
    v_mul_f32 v40, 0x3acccccd, v40
    v_mov_b32 v41, 0x3727c5ac
    v_fmac_f32 v41, 0x3acccccd, v48
    v_fma_f32 v41, -v40, v40, v41
    v_rsq_f32 v41, v41
    v_fma_f32 v32, -v40, v224, v32
    s_nop 0
    v_fma_f32 v32, v41, v32, v225
    v_max_f32 v32, 0, v32
    v_mul_f32 v32, v32, v32
    v_cvt_pk_bf16_f32 v32, v32, v32
    ds_write_b16 v244, v32
    s_waitcnt lgkmcnt(0)
    ds_read_b128 v[36:39], v245
    v_mov_b32 v70, 0
    v_mov_b32 v71, s8
    v_mov_b32 v74, 0
    v_mov_b32 v75, s8
    s_waitcnt lgkmcnt(0)
    v_mfma_f32_16x16x32_bf16 v[48:51], v[36:39], v[96:99], 0
    v_mfma_f32_16x16x32_bf16 v[52:55], v[36:39], v[100:103], 0
    v_mfma_f32_16x16x32_bf16 v[56:59], v[36:39], v[104:107], 0
    v_mfma_f32_16x16x32_bf16 v[60:63], v[36:39], v[108:111], 0
    v_mfma_f32_16x16x32_bf16 v[64:67], v[36:39], v[112:115], 0
    s_nop 4
    v_permlane16_swap_b32 v48, v52
    v_permlane16_swap_b32 v49, v53
    v_permlane16_swap_b32 v56, v60
    v_permlane16_swap_b32 v57, v61
    s_nop 1
    v_permlane32_swap_b32 v48, v56
    v_permlane32_swap_b32 v49, v57
    s_nop 1
    v_mov_b32 v68, v48
    v_mov_b32 v69, v49
    v_mov_b32 v72, v64
    v_mov_b32 v73, v65
    global_store_dwordx4 v246, v[68:71], s[46:47] sc1
    s_mov_b64 exec, 0xffff
    global_store_dwordx4 v246, v[72:75], s[46:47] offset:1024 sc1
    s_mov_b64 exec, -1
Lgend_62:
L_exit:
    s_endpgm
L_codeend:
.section .rodata,"a"
.p2align 6
.amdhsa_kernel adaLN_cond__compressed_kv_cla__dense_activation_squared_relu__decode_kernel
  .amdhsa_next_free_vgpr 256
  .amdhsa_next_free_sgpr 102
  .amdhsa_accum_offset 256
  .amdhsa_group_segment_fixed_size 0
  .amdhsa_kernarg_size 128
  .amdhsa_user_sgpr_count 2
  .amdhsa_user_sgpr_kernarg_segment_ptr 1
  .amdhsa_system_sgpr_workgroup_id_x 1
.end_amdhsa_kernel
```
